```python
import torch

def _softmax(x, axis=-1):
    return torch.softmax(x, dim=axis)
def _gelu(x):
    return torch.nn.functional.gelu(x, approximate="tanh")
def _silu(x):
    return torch.nn.functional.silu(x)
def _sigmoid(x):
    return torch.sigmoid(x)
def _layernorm(x, axis=-1, eps=1e-5):
    m = x.mean(dim=axis, keepdim=True)
    v = x.var(dim=axis, keepdim=True, unbiased=False)
    return (x - m) / torch.sqrt(v + eps)
def _scatter_add(tgt, idx, src, axis=0):
    return tgt.clone().index_add_(axis, idx, src)
def _segment_sum(src, seg, n):
    out = torch.zeros((n,) + src.shape[1:], dtype=src.dtype)
    return out.index_add_(0, seg, src)
def _pad(x, pw):
    flat = tuple(v for pair in reversed(pw) for v in pair)
    return torch.nn.functional.pad(x, flat)

kernel_name = 'gather_scatter__mpnn_edge_mlp__graph'

def setup_inputs():

    _w = (lambda a: (lambda t: t.to(torch.bfloat16) if t.is_floating_point() else t)(torch.as_tensor(a)))
    N, deg, D, De = 25000, 32, 64, max(0, 1)
    E = N * deg
    return {
        "x": _w((lambda *s: torch.randn(*s, dtype=torch.bfloat16) * 0.05)(N, D)),
        "e_attr": _w((lambda *s: torch.randn(*s, dtype=torch.bfloat16) * 0.4)(E, De)),
        "src": _w((lambda lo, hi, *s: torch.randint(lo, hi, s))(0, N, E).to(torch.int64)),
        "dst": _w((lambda lo, hi, *s: torch.randint(lo, hi, s))(0, N, E).to(torch.int64)),
        "w_msg": _w((lambda *s: torch.randn(*s, dtype=torch.bfloat16) * 0.4)(2 * D + De, D)),
        "w_upd": _w((lambda *s: torch.randn(*s, dtype=torch.bfloat16) * 0.05)(2 * D, D)),
    }

def reference(x, e_attr, src, dst, w_msg, w_upd):
    N, D = x.shape
    m_in = torch.concatenate([x[src], x[dst], e_attr], axis=-1)
    msg = _silu(m_in @ w_msg)
    agg = _segment_sum(msg, dst, N)
    return _silu(torch.concatenate([x, agg], axis=-1) @ w_upd)
```

```asm
; @launch kernel=mpnn_bin_kernel grid=(504,1,1) block=(448,1,1) lds=27712
; @launch kernel=mpnn_main_kernel grid=(256,1,1) block=(1024,1,1) lds=162592
.amdgcn_target "amdgcn-amd-amdhsa--gfx950"
.text
.globl mpnn_bin_kernel
.p2align 8
.type mpnn_bin_kernel,@function
mpnn_bin_kernel:
    s_load_dwordx16 s[4:19], s[0:1], 0
    s_load_dwordx2 s[20:21], s[0:1], 64
    s_cmp_ge_u32 s2, 504
    s_cbranch_scc1 A_done
    v_lshrrev_b32 v1, 6, v0
    v_lshlrev_b32 v3, 4, v0
    v_readfirstlane_b32 s3, v1
    v_and_b32 v1, 63, v0
    s_cmp_ge_u32 s2, 500
    s_cbranch_scc1 A_prep
    s_add_u32 s22, s2, 250
    s_sub_u32 s23, s2, 250
    s_cmp_lt_u32 s2, 250
    s_cselect_b32 s2, s22, s23
    s_cmp_ge_u32 s2, 250
    s_cbranch_scc1 A_gemm
    v_cmp_gt_u32 vcc, 400, v0
    s_and_b64 exec, exec, vcc
    v_lshlrev_b32 v2, 3, v0
    s_mul_i32 s44, s2, 12800
    s_mul_i32 s45, s2, 6400
    s_add_u32 s50, s44, 6400
    s_add_u32 s51, s45, 3200
    s_waitcnt lgkmcnt(0)
    s_mov_b32 s24, s10
    s_mov_b32 s25, s11
    s_mov_b32 s26, 0x30d400
    s_mov_b32 s27, 0x00020000
    buffer_load_dwordx4 v[8:11], v3, s[24:27], s44 offen nt
    buffer_load_dwordx4 v[12:15], v3, s[24:27], s50 offen nt
    s_mov_b32 s28, s8
    s_mov_b32 s29, s9
    s_mov_b32 s30, 0x30d400
    s_mov_b32 s31, 0x00020000
    s_mov_b32 s32, s6
    s_mov_b32 s33, s7
    s_mov_b32 s34, 0x186a00
    s_mov_b32 s35, 0x00020000
    v_lshlrev_b32 v5, 2, v0
    v_mov_b32 v4, 0
    v_mov_b32 v6, 2048
    v_cmp_gt_u32 vcc, 256, v0
    s_nop 1
    v_cndmask_b32 v5, v6, v5, vcc
    ds_write_b32 v5, v4
    s_mov_b32 s36, s20
    s_mov_b32 s37, s21
    s_mov_b32 s38, 0x61a800
    s_mov_b32 s39, 0x00020000
    s_add_u32 s40, s20, 0x700000
    s_addc_u32 s41, s21, 0
    s_mov_b32 s42, 0x3e800
    s_mov_b32 s43, 0x00020000
    s_mov_b32 s46, 42800
    s_mov_b32 s47, -196
    s_mov_b32 s48, 0xffff0000
    s_mov_b32 s52, 0x7fff7fff
    v_mov_b32 v4, 1
    s_waitcnt lgkmcnt(0)
    s_barrier
    s_waitcnt vmcnt(1)
    buffer_load_dwordx4 v[16:19], v3, s[28:31], s44 offen nt
    buffer_load_dwordx4 v[20:23], v3, s[28:31], s50 offen nt
    buffer_load_dwordx2 v[24:25], v2, s[32:35], s45 offen nt
    buffer_load_dwordx2 v[26:27], v2, s[32:35], s51 offen nt
    v_mul_u32_u24 v28, s46, v8
    v_lshrrev_b32 v28, 22, v28
    v_lshlrev_b32 v28, 2, v28
    ds_add_rtn_u32 v56, v28, v4
    v_mul_u32_u24 v29, s46, v9
    v_lshrrev_b32 v29, 22, v29
    v_lshlrev_b32 v29, 2, v29
    ds_add_rtn_u32 v57, v29, v4
    v_mul_u32_u24 v30, s46, v10
    v_lshrrev_b32 v30, 22, v30
    v_lshlrev_b32 v30, 2, v30
    ds_add_rtn_u32 v58, v30, v4
    v_mul_u32_u24 v31, s46, v11
    v_lshrrev_b32 v31, 22, v31
    v_lshlrev_b32 v31, 2, v31
    ds_add_rtn_u32 v59, v31, v4
    s_waitcnt vmcnt(4)
    v_mul_u32_u24 v32, s46, v12
    v_lshrrev_b32 v32, 22, v32
    v_lshlrev_b32 v32, 2, v32
    ds_add_rtn_u32 v60, v32, v4
    v_mul_u32_u24 v33, s46, v13
    v_lshrrev_b32 v33, 22, v33
    v_lshlrev_b32 v33, 2, v33
    ds_add_rtn_u32 v61, v33, v4
    v_mul_u32_u24 v34, s46, v14
    v_lshrrev_b32 v34, 22, v34
    v_lshlrev_b32 v34, 2, v34
    ds_add_rtn_u32 v62, v34, v4
    v_mul_u32_u24 v35, s46, v15
    v_lshrrev_b32 v35, 22, v35
    v_lshlrev_b32 v35, 2, v35
    ds_add_rtn_u32 v63, v35, v4
    v_lshlrev_b32 v8, 3, v8
    v_mad_i32_i24 v41, v28, s47, v8
    v_lshlrev_b32 v9, 3, v9
    v_mad_i32_i24 v43, v29, s47, v9
    v_lshlrev_b32 v10, 3, v10
    v_mad_i32_i24 v45, v30, s47, v10
    v_lshlrev_b32 v11, 3, v11
    v_mad_i32_i24 v47, v31, s47, v11
    v_lshlrev_b32 v12, 3, v12
    v_mad_i32_i24 v49, v32, s47, v12
    v_lshlrev_b32 v13, 3, v13
    v_mad_i32_i24 v51, v33, s47, v13
    v_lshlrev_b32 v14, 3, v14
    v_mad_i32_i24 v53, v34, s47, v14
    v_lshlrev_b32 v15, 3, v15
    v_mad_i32_i24 v55, v35, s47, v15
    s_mov_b64 s[22:23], exec
    s_waitcnt lgkmcnt(0)
    s_barrier
    s_mov_b64 exec, -1
    v_lshlrev_b32 v5, 4, v1
    ds_read_b128 v[8:11], v5
    s_waitcnt lgkmcnt(0)
    v_add_u32 v13, v8, v9
    v_add_u32 v14, v13, v10
    v_add_u32 v15, v14, v11
    v_mov_b32 v72, v15
    s_nop 1
    v_add_u32_dpp v72, v72, v72 row_shr:1 row_mask:0xf bank_mask:0xf bound_ctrl:0
    s_nop 1
    v_add_u32_dpp v72, v72, v72 row_shr:2 row_mask:0xf bank_mask:0xf bound_ctrl:0
    s_nop 1
    v_add_u32_dpp v72, v72, v72 row_shr:4 row_mask:0xf bank_mask:0xf bound_ctrl:0
    s_nop 1
    v_add_u32_dpp v72, v72, v72 row_shr:8 row_mask:0xf bank_mask:0xf bound_ctrl:0
    s_nop 1
    v_add_u32_dpp v72, v72, v72 row_bcast:15 row_mask:0xa bank_mask:0xf
    s_nop 1
    v_add_u32_dpp v72, v72, v72 row_bcast:31 row_mask:0xc bank_mask:0xf
    v_sub_u32 v12, v72, v15
    v_add_u32 v15, v12, v14
    v_add_u32 v14, v12, v13
    v_add_u32 v13, v12, v8
    v_lshlrev_b32 v72, 3, v12
    v_lshlrev_b32 v73, 3, v13
    v_lshlrev_b32 v74, 3, v14
    v_lshlrev_b32 v75, 3, v15
    ds_write_b128 v5, v[72:75] offset:1024
    v_lshl_or_b32 v64, v8, 16, v12
    v_lshl_or_b32 v65, v9, 16, v13
    v_lshl_or_b32 v66, v10, 16, v14
    v_lshl_or_b32 v67, v11, 16, v15
    s_mov_b64 exec, s[22:23]
    s_waitcnt lgkmcnt(0)
    ds_read_b32 v8, v28 offset:1024
    ds_read_b32 v9, v29 offset:1024
    ds_read_b32 v10, v30 offset:1024
    ds_read_b32 v11, v31 offset:1024
    ds_read_b32 v12, v32 offset:1024
    ds_read_b32 v13, v33 offset:1024
    ds_read_b32 v14, v34 offset:1024
    ds_read_b32 v15, v35 offset:1024
    s_waitcnt vmcnt(0)
    v_lshlrev_b32 v40, 16, v24
    v_lshl_or_b32 v41, v41, 16, v16
    v_and_b32 v42, s48, v24
    v_lshl_or_b32 v43, v43, 16, v17
    v_lshlrev_b32 v44, 16, v25
    v_lshl_or_b32 v45, v45, 16, v18
    v_and_b32 v46, s48, v25
    v_lshl_or_b32 v47, v47, 16, v19
    v_lshlrev_b32 v48, 16, v26
    v_lshl_or_b32 v49, v49, 16, v20
    v_and_b32 v50, s48, v26
    v_lshl_or_b32 v51, v51, 16, v21
    v_lshlrev_b32 v52, 16, v27
    v_lshl_or_b32 v53, v53, 16, v22
    v_and_b32 v54, s48, v27
    v_lshl_or_b32 v55, v55, 16, v23
    v_and_b32 v24, s52, v24
    v_and_b32 v25, s52, v25
    v_and_b32 v26, s52, v26
    v_and_b32 v27, s52, v27
    v_pk_max_u16 v24, v24, v25
    v_pk_max_u16 v26, v26, v27
    v_pk_max_u16 v24, v24, v26
    v_lshrrev_b32 v25, 16, v24
    v_and_b32 v24, 0xffff, v24
    v_max_u32 v24, v24, v25
    v_cmp_lt_u32 vcc, 0x4040, v24
    s_and_saveexec_b64 s[54:55], vcc
    s_cbranch_execz A_eok
    v_mov_b32 v25, 0x80000000
    ds_write_b32 v6, v25
A_eok:
    s_mov_b64 exec, s[54:55]
    s_waitcnt lgkmcnt(0)
    v_lshl_add_u32 v8, v56, 3, v8
    v_lshl_add_u32 v9, v57, 3, v9
    v_lshl_add_u32 v10, v58, 3, v10
    v_lshl_add_u32 v11, v59, 3, v11
    v_lshl_add_u32 v12, v60, 3, v12
    v_lshl_add_u32 v13, v61, 3, v13
    v_lshl_add_u32 v14, v62, 3, v14
    v_lshl_add_u32 v15, v63, 3, v15
    ds_write_b64 v8, v[40:41] offset:2112
    ds_write_b64 v9, v[42:43] offset:2112
    ds_write_b64 v10, v[44:45] offset:2112
    ds_write_b64 v11, v[46:47] offset:2112
    ds_write_b64 v12, v[48:49] offset:2112
    ds_write_b64 v13, v[50:51] offset:2112
    ds_write_b64 v14, v[52:53] offset:2112
    ds_write_b64 v15, v[54:55] offset:2112
    s_waitcnt lgkmcnt(0)
    s_barrier
    s_cmp_lg_u32 s3, 6
    s_cbranch_scc1 A_notab
    s_mov_b64 exec, -1
    v_mov_b32 v6, 2048
    ds_read_b32 v7, v6
    s_lshl_b32 s49, s2, 10
    s_waitcnt lgkmcnt(0)
    v_or_b32 v64, v64, v7
    v_or_b32 v65, v65, v7
    v_or_b32 v66, v66, v7
    v_or_b32 v67, v67, v7
    buffer_store_dwordx4 v[64:67], v5, s[40:43], s49 offen sc0 sc1
    s_mov_b64 exec, s[22:23]
A_notab:
    ds_read_b128 v[8:11], v3 offset:2112
    ds_read_b128 v[12:15], v3 offset:8512
    ds_read_b128 v[16:19], v3 offset:14912
    ds_read_b128 v[20:23], v3 offset:21312
    s_mul_i32 s49, s2, 25600
    s_waitcnt lgkmcnt(3)
    buffer_store_dwordx4 v[8:11], v3, s[36:39], s49 offen sc0 sc1
    s_add_u32 s49, s49, 6400
    s_waitcnt lgkmcnt(2)
    buffer_store_dwordx4 v[12:15], v3, s[36:39], s49 offen sc0 sc1
    s_add_u32 s49, s49, 6400
    s_waitcnt lgkmcnt(1)
    buffer_store_dwordx4 v[16:19], v3, s[36:39], s49 offen sc0 sc1
    s_add_u32 s49, s49, 6400
    s_waitcnt lgkmcnt(0)
    buffer_store_dwordx4 v[20:23], v3, s[36:39], s49 offen sc0 sc1
    s_endpgm
A_gemm:
    s_sub_u32 s22, s2, 250
    s_mul_i32 s48, s22, 12800
    s_add_u32 s49, s48, 12800
    s_lshl_b32 s22, s22, 2
    s_add_u32 s22, s22, s3
    v_and_b32 v2, 31, v1
    v_lshrrev_b32 v3, 5, v1
    v_lshlrev_b32 v4, 2, v2
    v_lshl_add_u32 v7, v3, 9, v4
    v_lshl_add_u32 v4, v3, 10, v4
    v_add_u32 v4, 16384, v4
    v_lshlrev_b32 v5, 4, v0
    s_lshl_b32 s23, s3, 12
    s_add_u32 s23, s23, s48
    v_lshlrev_b32 v6, 4, v1
    s_lshl_b32 s42, s3, 12
    v_add_u32 v7, s42, v7
    v_lshrrev_b32 v8, 3, v1
    v_and_b32 v9, 7, v1
    v_xor_b32 v10, v9, v8
    v_lshlrev_b32 v10, 4, v10
    v_lshl_add_u32 v10, v8, 7, v10
    v_add_u32 v10, s42, v10
    v_xor_b32 v9, v9, v3
    v_lshlrev_b32 v8, 7, v2
    v_add_u32 v8, s42, v8
    v_xor_b32 v11, 0, v9
    v_lshl_add_u32 v11, v11, 4, v8
    v_xor_b32 v12, 2, v9
    v_lshl_add_u32 v12, v12, 4, v8
    v_xor_b32 v13, 4, v9
    v_lshl_add_u32 v13, v13, 4, v8
    v_xor_b32 v14, 6, v9
    v_lshl_add_u32 v14, v14, 4, v8
    s_waitcnt lgkmcnt(0)
    s_mov_b32 s24, s4
    s_mov_b32 s25, s5
    s_mov_b32 s26, 0x30d400
    s_mov_b32 s27, 0x00020000
    s_mov_b32 s26, s49
    s_mov_b32 s28, s12
    s_mov_b32 s29, s13
    s_mov_b32 s30, 0x2000
    s_mov_b32 s31, 0x00020000
    s_movk_i32 s43, 7168
    buffer_load_dwordx4 v[16:19], v5, s[28:31], 0 offen
    buffer_load_dwordx4 v[20:23], v5, s[28:31], s43 offen
    buffer_load_dwordx4 v[48:51], v6, s[24:27], s23 offen offset:0
    buffer_load_dwordx4 v[52:55], v6, s[24:27], s23 offen offset:1024
    buffer_load_dwordx4 v[56:59], v6, s[24:27], s23 offen offset:2048
    buffer_load_dwordx4 v[60:63], v6, s[24:27], s23 offen offset:3072
    s_add_u32 s32, s20, 0x800000
    s_addc_u32 s33, s21, 0
    s_mov_b32 s34, 0x30d400
    s_mov_b32 s35, 0x00020000
    s_mov_b32 s34, s49
    s_add_u32 s44, s20, 0x780000
    s_addc_u32 s45, s21, 0
    s_mov_b32 s46, 0xfa0
    s_mov_b32 s47, 0x00020000
    s_mov_b32 s36, 0x05040100
    s_mov_b32 s37, 0x07060302
    s_mov_b32 s38, 0xbfb8aa3b
    s_mov_b32 s39, 0x7fffffff
    s_mov_b32 s40, 0x7fff0000
    s_mov_b32 s41, 0x40400000
    s_waitcnt vmcnt(4)
    ds_write_b128 v5, v[16:19] offset:16384
    s_cmp_lg_u32 s3, 0
    s_cbranch_scc1 A_w1done
    ds_write_b128 v5, v[20:23] offset:23552
A_w1done:
    s_waitcnt lgkmcnt(0)
    s_barrier
    s_cmp_ge_u32 s3, 4
    s_cbranch_scc1 A_done
    ds_read2_b32 v[16:17], v4 offset0:0 offset1:32
    ds_read2_b32 v[18:19], v4 offset0:64 offset1:96
    ds_read2_b32 v[20:21], v4 offset0:128 offset1:160
    ds_read2_b32 v[22:23], v4 offset0:192 offset1:224
    v_add_u32 v4, 2048, v4
    ds_read2_b32 v[24:25], v4 offset0:0 offset1:32
    ds_read2_b32 v[26:27], v4 offset0:64 offset1:96
    ds_read2_b32 v[28:29], v4 offset0:128 offset1:160
    ds_read2_b32 v[30:31], v4 offset0:192 offset1:224
    v_add_u32 v4, 2048, v4
    ds_read2_b32 v[32:33], v4 offset0:0 offset1:32
    ds_read2_b32 v[34:35], v4 offset0:64 offset1:96
    ds_read2_b32 v[36:37], v4 offset0:128 offset1:160
    ds_read2_b32 v[38:39], v4 offset0:192 offset1:224
    v_add_u32 v4, 2048, v4
    ds_read2_b32 v[40:41], v4 offset0:0 offset1:32
    ds_read2_b32 v[42:43], v4 offset0:64 offset1:96
    ds_read2_b32 v[44:45], v4 offset0:128 offset1:160
    ds_read2_b32 v[46:47], v4 offset0:192 offset1:224
    s_waitcnt vmcnt(0)
    ds_write_b128 v10, v[48:51] offset:0
    ds_write_b128 v10, v[52:55] offset:1024
    ds_write_b128 v10, v[56:59] offset:2048
    ds_write_b128 v10, v[60:63] offset:3072
    s_waitcnt lgkmcnt(0)
    ds_read_b128 v[48:51], v11
    ds_read_b128 v[52:55], v12
    ds_read_b128 v[56:59], v13
    ds_read_b128 v[60:63], v14
    v_perm_b32 v64, v17, v16, s36
    v_perm_b32 v80, v17, v16, s37
    v_perm_b32 v65, v19, v18, s36
    v_perm_b32 v81, v19, v18, s37
    v_perm_b32 v66, v21, v20, s36
    v_perm_b32 v82, v21, v20, s37
    v_perm_b32 v67, v23, v22, s36
    v_perm_b32 v83, v23, v22, s37
    v_perm_b32 v68, v25, v24, s36
    v_perm_b32 v84, v25, v24, s37
    v_perm_b32 v69, v27, v26, s36
    v_perm_b32 v85, v27, v26, s37
    v_perm_b32 v70, v29, v28, s36
    v_perm_b32 v86, v29, v28, s37
    v_perm_b32 v71, v31, v30, s36
    v_perm_b32 v87, v31, v30, s37
    v_perm_b32 v72, v33, v32, s36
    v_perm_b32 v88, v33, v32, s37
    v_perm_b32 v73, v35, v34, s36
    v_perm_b32 v89, v35, v34, s37
    v_perm_b32 v74, v37, v36, s36
    v_perm_b32 v90, v37, v36, s37
    v_perm_b32 v75, v39, v38, s36
    v_perm_b32 v91, v39, v38, s37
    v_perm_b32 v76, v41, v40, s36
    v_perm_b32 v92, v41, v40, s37
    v_perm_b32 v77, v43, v42, s36
    v_perm_b32 v93, v43, v42, s37
    v_perm_b32 v78, v45, v44, s36
    v_perm_b32 v94, v45, v44, s37
    v_perm_b32 v79, v47, v46, s36
    v_perm_b32 v95, v47, v46, s37
    s_waitcnt lgkmcnt(0)
    v_mfma_f32_32x32x16_bf16 v[96:111], v[48:51], v[64:67], 0
    v_mfma_f32_32x32x16_bf16 v[112:127], v[48:51], v[80:83], 0
    v_mfma_f32_32x32x16_bf16 v[96:111], v[52:55], v[68:71], v[96:111]
    v_mfma_f32_32x32x16_bf16 v[112:127], v[52:55], v[84:87], v[112:127]
    v_mfma_f32_32x32x16_bf16 v[96:111], v[56:59], v[72:75], v[96:111]
    v_mfma_f32_32x32x16_bf16 v[112:127], v[56:59], v[88:91], v[112:127]
    v_mfma_f32_32x32x16_bf16 v[96:111], v[60:63], v[76:79], v[96:111]
    v_mfma_f32_32x32x16_bf16 v[112:127], v[60:63], v[92:95], v[112:127]
    s_nop 15
    v_mul_f32 v96, s38, v96
    v_mul_f32 v97, s38, v97
    v_mul_f32 v98, s38, v98
    v_mul_f32 v99, s38, v99
    v_mul_f32 v100, s38, v100
    v_mul_f32 v101, s38, v101
    v_mul_f32 v102, s38, v102
    v_mul_f32 v103, s38, v103
    v_mul_f32 v104, s38, v104
    v_mul_f32 v105, s38, v105
    v_mul_f32 v106, s38, v106
    v_mul_f32 v107, s38, v107
    v_mul_f32 v108, s38, v108
    v_mul_f32 v109, s38, v109
    v_mul_f32 v110, s38, v110
    v_mul_f32 v111, s38, v111
    v_mul_f32 v112, s38, v112
    v_mul_f32 v113, s38, v113
    v_mul_f32 v114, s38, v114
    v_mul_f32 v115, s38, v115
    v_mul_f32 v116, s38, v116
    v_mul_f32 v117, s38, v117
    v_mul_f32 v118, s38, v118
    v_mul_f32 v119, s38, v119
    v_mul_f32 v120, s38, v120
    v_mul_f32 v121, s38, v121
    v_mul_f32 v122, s38, v122
    v_mul_f32 v123, s38, v123
    v_mul_f32 v124, s38, v124
    v_mul_f32 v125, s38, v125
    v_mul_f32 v126, s38, v126
    v_mul_f32 v127, s38, v127
    v_cvt_pk_bf16_f32 v16, v96, v97
    v_cvt_pk_bf16_f32 v18, v98, v99
    v_cvt_pk_bf16_f32 v20, v100, v101
    v_cvt_pk_bf16_f32 v22, v102, v103
    v_cvt_pk_bf16_f32 v24, v104, v105
    v_cvt_pk_bf16_f32 v26, v106, v107
    v_cvt_pk_bf16_f32 v28, v108, v109
    v_cvt_pk_bf16_f32 v30, v110, v111
    v_lshrrev_b32 v17, 16, v16
    v_and_b32 v16, 0xffff, v16
    v_lshrrev_b32 v19, 16, v18
    v_and_b32 v18, 0xffff, v18
    v_lshrrev_b32 v21, 16, v20
    v_and_b32 v20, 0xffff, v20
    v_lshrrev_b32 v23, 16, v22
    v_and_b32 v22, 0xffff, v22
    v_lshrrev_b32 v25, 16, v24
    v_and_b32 v24, 0xffff, v24
    v_lshrrev_b32 v27, 16, v26
    v_and_b32 v26, 0xffff, v26
    v_lshrrev_b32 v29, 16, v28
    v_and_b32 v28, 0xffff, v28
    v_lshrrev_b32 v31, 16, v30
    v_and_b32 v30, 0xffff, v30
    v_and_b32 v32, s39, v112
    v_and_b32 v33, s39, v113
    v_and_b32 v34, s39, v114
    v_and_b32 v35, s39, v115
    v_and_b32 v36, s39, v116
    v_and_b32 v37, s39, v117
    v_and_b32 v38, s39, v118
    v_and_b32 v39, s39, v119
    v_and_b32 v40, s39, v120
    v_and_b32 v41, s39, v121
    v_and_b32 v42, s39, v122
    v_and_b32 v43, s39, v123
    v_and_b32 v44, s39, v124
    v_and_b32 v45, s39, v125
    v_and_b32 v46, s39, v126
    v_and_b32 v47, s39, v127
    v_add_u32 v32, 0x8000, v32
    v_add_u32 v33, 0x8000, v33
    v_add_u32 v34, 0x8000, v34
    v_add_u32 v35, 0x8000, v35
    v_add_u32 v36, 0x8000, v36
    v_add_u32 v37, 0x8000, v37
    v_add_u32 v38, 0x8000, v38
    v_add_u32 v39, 0x8000, v39
    v_add_u32 v40, 0x8000, v40
    v_add_u32 v41, 0x8000, v41
    v_add_u32 v42, 0x8000, v42
    v_add_u32 v43, 0x8000, v43
    v_add_u32 v44, 0x8000, v44
    v_add_u32 v45, 0x8000, v45
    v_add_u32 v46, 0x8000, v46
    v_add_u32 v47, 0x8000, v47
    v_sub_u32 v32, v32, v16 clamp
    v_sub_u32 v33, v33, v17 clamp
    v_sub_u32 v34, v34, v18 clamp
    v_sub_u32 v35, v35, v19 clamp
    v_sub_u32 v36, v36, v20 clamp
    v_sub_u32 v37, v37, v21 clamp
    v_sub_u32 v38, v38, v22 clamp
    v_sub_u32 v39, v39, v23 clamp
    v_sub_u32 v40, v40, v24 clamp
    v_sub_u32 v41, v41, v25 clamp
    v_sub_u32 v42, v42, v26 clamp
    v_sub_u32 v43, v43, v27 clamp
    v_sub_u32 v44, v44, v28 clamp
    v_sub_u32 v45, v45, v29 clamp
    v_sub_u32 v46, v46, v30 clamp
    v_sub_u32 v47, v47, v31 clamp
    v_and_or_b32 v32, v32, s40, v16
    v_and_or_b32 v33, v33, s40, v17
    v_and_or_b32 v34, v34, s40, v18
    v_and_or_b32 v35, v35, s40, v19
    v_and_or_b32 v36, v36, s40, v20
    v_and_or_b32 v37, v37, s40, v21
    v_and_or_b32 v38, v38, s40, v22
    v_and_or_b32 v39, v39, s40, v23
    v_and_or_b32 v40, v40, s40, v24
    v_and_or_b32 v41, v41, s40, v25
    v_and_or_b32 v42, v42, s40, v26
    v_and_or_b32 v43, v43, s40, v27
    v_and_or_b32 v44, v44, s40, v28
    v_and_or_b32 v45, v45, s40, v29
    v_and_or_b32 v46, v46, s40, v30
    v_and_or_b32 v47, v47, s40, v31
    v_bfi_b32 v32, s39, v32, v112
    ds_write_b32 v7, v32 offset:0
    v_bfi_b32 v33, s39, v33, v113
    ds_write_b32 v7, v33 offset:128
    v_bfi_b32 v34, s39, v34, v114
    ds_write_b32 v7, v34 offset:256
    v_bfi_b32 v35, s39, v35, v115
    ds_write_b32 v7, v35 offset:384
    v_bfi_b32 v36, s39, v36, v116
    ds_write_b32 v7, v36 offset:1024
    v_bfi_b32 v37, s39, v37, v117
    ds_write_b32 v7, v37 offset:1152
    v_bfi_b32 v38, s39, v38, v118
    ds_write_b32 v7, v38 offset:1280
    v_bfi_b32 v39, s39, v39, v119
    ds_write_b32 v7, v39 offset:1408
    v_bfi_b32 v40, s39, v40, v120
    ds_write_b32 v7, v40 offset:2048
    v_bfi_b32 v41, s39, v41, v121
    ds_write_b32 v7, v41 offset:2176
    v_bfi_b32 v42, s39, v42, v122
    ds_write_b32 v7, v42 offset:2304
    v_bfi_b32 v43, s39, v43, v123
    ds_write_b32 v7, v43 offset:2432
    v_bfi_b32 v44, s39, v44, v124
    ds_write_b32 v7, v44 offset:3072
    v_bfi_b32 v45, s39, v45, v125
    ds_write_b32 v7, v45 offset:3200
    v_bfi_b32 v46, s39, v46, v126
    ds_write_b32 v7, v46 offset:3328
    v_bfi_b32 v47, s39, v47, v127
    ds_write_b32 v7, v47 offset:3456
    v_add_u32 v8, s42, v6
    s_waitcnt lgkmcnt(0)
    ds_read_b128 v[48:51], v8 offset:0
    ds_read_b128 v[52:55], v8 offset:1024
    ds_read_b128 v[56:59], v8 offset:2048
    ds_read_b128 v[60:63], v8 offset:3072
    v_max_f32 v64, |v96|, |v97|
    v_max3_f32 v64, v64, |v98|, |v99|
    v_max3_f32 v64, v64, |v100|, |v101|
    v_max3_f32 v64, v64, |v102|, |v103|
    v_max3_f32 v64, v64, |v104|, |v105|
    v_max3_f32 v64, v64, |v106|, |v107|
    v_max3_f32 v64, v64, |v108|, |v109|
    v_max3_f32 v64, v64, |v110|, |v111|
    v_max3_f32 v64, v64, |v112|, |v113|
    v_max3_f32 v64, v64, |v114|, |v115|
    v_max3_f32 v64, v64, |v116|, |v117|
    v_max3_f32 v64, v64, |v118|, |v119|
    v_max3_f32 v64, v64, |v120|, |v121|
    v_max3_f32 v64, v64, |v122|, |v123|
    v_max3_f32 v64, v64, |v124|, |v125|
    v_max3_f32 v64, v64, |v126|, |v127|
    v_cmp_lt_f32 vcc, s41, v64
    s_waitcnt lgkmcnt(3)
    buffer_store_dwordx4 v[48:51], v6, s[32:35], s23 offen offset:0 sc0 sc1
    s_waitcnt lgkmcnt(2)
    buffer_store_dwordx4 v[52:55], v6, s[32:35], s23 offen offset:1024 sc0 sc1
    s_waitcnt lgkmcnt(1)
    buffer_store_dwordx4 v[56:59], v6, s[32:35], s23 offen offset:2048 sc0 sc1
    s_waitcnt lgkmcnt(0)
    buffer_store_dwordx4 v[60:63], v6, s[32:35], s23 offen offset:3072 sc0 sc1
    s_lshl_b32 s43, s22, 2
    v_mov_b32 v66, 0
    s_cmp_lg_u64 vcc, 0
    s_cselect_b32 s42, 1, 0
    v_mov_b32 v65, s42
    s_mov_b64 exec, 1
    buffer_store_dword v65, v66, s[44:47], s43 offen sc0 sc1
    s_endpgm
A_prep:
    s_sub_u32 s50, s2, 500
    s_mul_i32 s50, s50, 7
    s_add_u32 s50, s50, s3
    s_cmp_gt_u32 s50, 24
    s_cbranch_scc1 A_done
    s_lshr_b32 s22, s50, 3
    s_bfe_u32 s23, s50, 0x10002
    s_and_b32 s24, s50, 3
    v_and_b32 v2, 31, v1
    v_lshrrev_b32 v3, 5, v1
    v_bfe_u32 v4, v2, 2, 1
    v_and_b32 v5, 3, v2
    v_lshrrev_b32 v6, 3, v2
    v_lshl_add_u32 v5, v6, 2, v5
    s_waitcnt lgkmcnt(0)
    s_add_u32 s32, s20, 0x7c0000
    s_addc_u32 s33, s21, 0
    s_mov_b32 s34, 0x6200
    s_mov_b32 s35, 0x00020000
    s_cmp_eq_u32 s50, 24
    s_cbranch_scc1 A_prep_w3
    s_cmp_lg_u32 s22, 0
    s_cbranch_scc1 A_prep_u
    s_mov_b32 s28, s12
    s_mov_b32 s29, s13
    s_mov_b32 s30, 0x4080
    s_mov_b32 s31, 0x00020000
    v_lshrrev_b32 v6, 3, v5
    v_lshl_add_u32 v6, v4, 2, v6
    s_lshl_b32 s25, s23, 1
    v_add_u32 v6, s25, v6
    v_and_b32 v7, 7, v5
    v_lshlrev_b32 v8, 1, v7
    v_add_u32 v9, 1, v8
    v_subrev_u32 v8, 8, v8
    v_cmp_gt_u32 vcc, 4, v7
    s_nop 1
    v_cndmask_b32 v8, v8, v9, vcc
    v_lshl_add_u32 v8, v6, 3, v8
    v_lshlrev_b32 v8, 1, v8
    v_lshl_add_u32 v8, v3, 10, v8
    s_lshl_b32 s26, s24, 11
    s_add_u32 s26, s26, 8192
    buffer_load_ushort v32, v8, s[28:31], s26 offen offset:0
    buffer_load_ushort v33, v8, s[28:31], s26 offen offset:128
    buffer_load_ushort v34, v8, s[28:31], s26 offen offset:256
    buffer_load_ushort v35, v8, s[28:31], s26 offen offset:384
    buffer_load_ushort v36, v8, s[28:31], s26 offen offset:512
    buffer_load_ushort v37, v8, s[28:31], s26 offen offset:640
    buffer_load_ushort v38, v8, s[28:31], s26 offen offset:768
    buffer_load_ushort v39, v8, s[28:31], s26 offen offset:896
    s_branch A_prep_st
A_prep_u:
    s_mov_b32 s28, s14
    s_mov_b32 s29, s15
    s_mov_b32 s30, 0x4000
    s_mov_b32 s31, 0x00020000
    v_lshl_add_u32 v8, v4, 4, v5
    s_lshl_b32 s25, s23, 5
    v_add_u32 v8, s25, v8
    v_lshlrev_b32 v8, 1, v8
    s_cmp_lg_u32 s22, 1
    s_cbranch_scc1 A_prep_agg
    v_lshl_add_u32 v8, v3, 10, v8
    s_lshl_b32 s26, s24, 11
    buffer_load_ushort v32, v8, s[28:31], s26 offen offset:0
    buffer_load_ushort v33, v8, s[28:31], s26 offen offset:128
    buffer_load_ushort v34, v8, s[28:31], s26 offen offset:256
    buffer_load_ushort v35, v8, s[28:31], s26 offen offset:384
    buffer_load_ushort v36, v8, s[28:31], s26 offen offset:512
    buffer_load_ushort v37, v8, s[28:31], s26 offen offset:640
    buffer_load_ushort v38, v8, s[28:31], s26 offen offset:768
    buffer_load_ushort v39, v8, s[28:31], s26 offen offset:896
    s_branch A_prep_st
A_prep_w3:
    s_add_u32 s44, s20, 0xb0d400
    s_addc_u32 s45, s21, 0
    s_mov_b32 s46, 0x80
    s_mov_b32 s47, 0x00020000
    v_mov_b32 v20, 0x71497149
    v_mov_b32 v21, v20
    v_mov_b32 v22, v20
    v_mov_b32 v23, v20
    v_lshlrev_b32 v24, 4, v1
    buffer_store_dwordx4 v[20:23], v24, s[44:47], 0 offen
    s_mov_b32 s36, s12
    s_mov_b32 s37, s13
    s_mov_b32 s38, 0x4080
    s_mov_b32 s39, 0x00020000
    v_and_b32 v10, 7, v1
    v_lshlrev_b32 v11, 4, v10
    s_movk_i32 s27, 0x4000
    buffer_load_dwordx4 v[44:47], v11, s[36:39], s27 offen
    s_mov_b32 s40, 0xbfb8aa3b
    s_waitcnt vmcnt(0)
    v_and_b32 v48, 0xffff0000, v44
    v_lshlrev_b32 v52, 16, v44
    v_and_b32 v49, 0xffff0000, v45
    v_lshlrev_b32 v53, 16, v45
    v_and_b32 v50, 0xffff0000, v46
    v_lshlrev_b32 v54, 16, v46
    v_and_b32 v51, 0xffff0000, v47
    v_lshlrev_b32 v55, 16, v47
    v_mul_f32 v48, s40, v48
    v_mul_f32 v49, s40, v49
    v_mul_f32 v50, s40, v50
    v_mul_f32 v51, s40, v51
    v_mul_f32 v52, s40, v52
    v_mul_f32 v53, s40, v53
    v_mul_f32 v54, s40, v54
    v_mul_f32 v55, s40, v55
    v_max3_f32 v44, |v48|, |v49|, |v50|
    v_max3_f32 v44, v44, |v51|, |v52|
    v_max3_f32 v44, v44, |v53|, |v54|
    v_max_f32 v44, v44, |v55|
    v_cmp_lt_f32 vcc, 0x40400000, v44
    v_lshlrev_b32 v11, 5, v10
    s_cmp_lg_u64 vcc, 0
    s_cselect_b32 s41, 1, 0
    v_mov_b32 v45, s41
    v_mov_b32 v46, 0
    s_movk_i32 s27, 24576
    buffer_store_dwordx4 v[48:51], v11, s[32:35], s27 offen
    buffer_store_dwordx4 v[52:55], v11, s[32:35], s27 offen offset:16
    buffer_store_dword v45, v46, s[32:35], s27 offen offset:256
    s_endpgm
A_prep_agg:
    v_lshl_add_u32 v8, v3, 11, v8
    s_and_b32 s26, s24, 1
    s_lshl_b32 s26, s26, 5
    s_lshr_b32 s27, s24, 1
    s_lshl_b32 s27, s27, 1
    s_add_u32 s26, s26, s27
    s_add_u32 s26, s26, 64
    s_lshl_b32 s26, s26, 7
    buffer_load_ushort v32, v8, s[28:31], s26 offen offset:128
    buffer_load_ushort v33, v8, s[28:31], s26 offen offset:1152
    buffer_load_ushort v34, v8, s[28:31], s26 offen offset:640
    buffer_load_ushort v35, v8, s[28:31], s26 offen offset:1664
    buffer_load_ushort v36, v8, s[28:31], s26 offen offset:0
    buffer_load_ushort v37, v8, s[28:31], s26 offen offset:1024
    buffer_load_ushort v38, v8, s[28:31], s26 offen offset:512
    buffer_load_ushort v39, v8, s[28:31], s26 offen offset:1536
A_prep_st:
    s_lshl_b32 s25, s50, 10
    v_lshlrev_b32 v9, 4, v1
    s_waitcnt vmcnt(0)
    v_lshl_or_b32 v16, v33, 16, v32
    v_lshl_or_b32 v17, v35, 16, v34
    v_lshl_or_b32 v18, v37, 16, v36
    v_lshl_or_b32 v19, v39, 16, v38
    buffer_store_dwordx4 v[16:19], v9, s[32:35], s25 offen
A_done:
    s_endpgm
.globl mpnn_main_kernel
.p2align 8
.type mpnn_main_kernel,@function
mpnn_main_kernel:
    s_load_dwordx2 s[80:81], s[0:1], 64
    s_load_dwordx16 s[64:79], s[0:1], 0
    s_cmp_ge_u32 s2, 256
    s_cbranch_scc1 B_done
    v_lshrrev_b32 v1, 6, v0
    v_lshrrev_b32 v4, 3, v0
    v_readfirstlane_b32 s3, v1
    v_lshlrev_b32 v12, 10, v4
    s_and_b32 s85, s2, 7
    s_lshl_b32 s85, s85, 5
    s_lshr_b32 s86, s2, 3
    s_add_u32 s85, s85, s86
    s_lshl_b32 s32, s85, 2
    s_add_u32 s33, s32, 0x20000
    v_and_b32 v1, 63, v0
    v_and_b32 v3, 7, v0
    v_lshlrev_b32 v2, 4, v3
    v_lshlrev_b32 v11, 4, v1
    s_mul_i32 s37, s85, 98
    s_lshl_b32 s39, s37, 7
    s_lshl_b32 s40, s3, 10
    s_add_u32 s39, s39, s40
    s_and_b32 s34, s3, 1
    s_lshl_b32 s41, s34, 12
    s_waitcnt lgkmcnt(0)
    s_add_u32 s4, s80, 0x700000
    s_addc_u32 s5, s81, 0
    s_mov_b32 s6, 0x3e800
    s_mov_b32 s7, 0x00020000
    buffer_load_dword v6, v12, s[4:7], s32 offen
    buffer_load_dword v7, v12, s[4:7], s33 offen
    s_mov_b32 s8, s80
    s_mov_b32 s9, s81
    s_mov_b32 s10, 0x61a800
    s_mov_b32 s11, 0x00020000
    s_add_u32 s28, s80, 0x7c6100
    s_addc_u32 s29, s81, 0
    s_load_dword s90, s[28:29], 0
    s_add_u32 s12, s80, 0x800000
    s_addc_u32 s13, s81, 0
    s_mov_b32 s14, 0x30d480
    s_mov_b32 s15, 0x00020000
    s_mov_b32 s24, s76
    s_mov_b32 s25, s77
    s_mov_b32 s26, 0x30d400
    s_mov_b32 s27, 0x00020000
    s_mov_b64 s[88:89], s[80:81]
    s_bfe_u32 s35, s3, 0x20001
    s_lshl_b32 s38, s35, 5
    v_and_b32 v8, 31, v1
    v_add_u32 v8, s38, v8
    v_lshrrev_b32 v9, 5, v1
    v_lshlrev_b32 v3, 3, v3
    v_add_u32 v3, 83808, v3
    s_movk_i32 s42, 128
    s_movk_i32 s43, 66
    s_mov_b32 s44, 1.0
    s_mov_b32 s45, 1.0
    s_mov_b32 s46, 0x3f80
    s_mov_b32 s47, 0xbfb8aa3b
    s_mov_b32 s48, 0xbf317218
    s_mov_b32 s49, 0xbf317218
    s_mov_b32 s50, 0
    s_mov_b32 s94, s47
    s_mov_b32 s95, s47
    s_movk_i32 s84, 72
    s_mov_b32 s86, 0
    s_mov_b32 s87, -1
    s_mov_b32 s16, s64
    s_mov_b32 s17, s65
    s_mov_b32 s18, 0x30d400
    s_mov_b32 s19, 0x00020000
    s_add_u32 s20, s80, 0x7c0000
    s_addc_u32 s21, s81, 0
    s_mov_b32 s22, 0x6200
    s_mov_b32 s23, 0x00020000
    s_add_u32 s28, s80, 0x780000
    s_addc_u32 s29, s81, 0
    s_mov_b32 s30, 0xfa0
    s_mov_b32 s31, 0x00020000
    s_cmp_lg_u32 s3, 15
    s_cbranch_scc1 B_batch
    s_mov_b32 m0, 162336
    s_movk_i32 s51, 24576
    s_mov_b64 exec, 0xffff
    buffer_load_dwordx4 v11, s[20:23], s51 offen lds
    s_mov_b64 exec, -1
    s_waitcnt vmcnt(0)
B_batch:
    v_lshlrev_b32 v12, 4, v0
    s_cmp_ge_u32 s3, 4
    s_cbranch_scc1 B_noini
    v_mov_b32 v16, 0xca20ca20
    v_cmp_gt_u32 vcc, 66, v0
    v_mov_b32 v28, 0
    v_mov_b32 v29, 0x31061a8
    v_cndmask_b32 v16, v16, v28, vcc
    v_mov_b32 v30, 0
    v_mov_b32 v31, 0x31061a8
    v_mov_b32 v17, v16
    v_mov_b32 v18, v16
    v_mov_b32 v19, v16
    v_cmp_gt_u32 vcc, 218, v0
    s_and_saveexec_b64 s[68:69], vcc
    ds_write_b128 v12, v[16:19]
    s_mov_b64 exec, 15
    ds_write_b128 v11, v[28:31] offset:55232
    s_mov_b64 exec, s[68:69]
B_noini:
    v_and_b32 v14, 7, v0
    v_lshlrev_b32 v14, 1, v14
    v_add_u32 v14, s50, v14
    s_movk_i32 s51, 3200
    v_mul_u32_u24 v15, s51, v4
    v_add_u32 v15, v15, v14
    v_mov_b32 v25, 0x7fffff00
    s_waitcnt lgkmcnt(0)
    s_barrier
    s_waitcnt vmcnt(0)
    v_bfe_u32 v20, v6, 16, 13
    v_and_b32 v22, 0xffff, v6
    v_add_u32 v22, v22, v15
    v_lshlrev_b32 v22, 3, v22
    v_sub_u32 v16, v20, v14
    v_bfe_u32 v21, v7, 16, 13
    v_and_b32 v23, 0xffff, v7
    v_add_u32 v23, v23, v15
    v_add_u32 v23, 409600, v23
    v_lshlrev_b32 v23, 3, v23
    v_sub_u32 v17, v21, v14
    v_cmp_lt_i32 s[52:53], 0, v16
    v_cmp_lt_i32 s[54:55], 1, v16
    v_cmp_lt_i32 s[56:57], 16, v16
    v_cmp_lt_i32 s[58:59], 17, v16
    v_cmp_lt_i32 s[60:61], 0, v17
    v_cmp_lt_i32 s[62:63], 1, v17
    v_cmp_lt_i32 s[64:65], 16, v17
    v_cmp_lt_i32 s[66:67], 17, v17
    s_cmp_eq_u32 s87, -1
    s_cbranch_scc1 B_allsl
    s_lshl_b32 s51, s3, 3
    s_sub_u32 s51, s87, s51
    s_cmp_eq_u32 s51, 0
    s_cselect_b64 s[52:53], s[52:53], 0
    s_cmp_eq_u32 s51, 1
    s_cselect_b64 s[54:55], s[54:55], 0
    s_cmp_eq_u32 s51, 2
    s_cselect_b64 s[56:57], s[56:57], 0
    s_cmp_eq_u32 s51, 3
    s_cselect_b64 s[58:59], s[58:59], 0
    s_cmp_eq_u32 s51, 4
    s_cselect_b64 s[60:61], s[60:61], 0
    s_cmp_eq_u32 s51, 5
    s_cselect_b64 s[62:63], s[62:63], 0
    s_cmp_eq_u32 s51, 6
    s_cselect_b64 s[64:65], s[64:65], 0
    s_cmp_eq_u32 s51, 7
    s_cselect_b64 s[66:67], s[66:67], 0
B_allsl:
    s_or_b64 vcc, s[52:53], s[54:55]
    v_cndmask_b32 v26, v25, v22, vcc
    buffer_load_dwordx4 v[96:99], v26, s[8:11], 0 offen offset:0
    s_or_b64 vcc, s[60:61], s[62:63]
    v_cndmask_b32 v28, v25, v23, vcc
    buffer_load_dwordx4 v[104:107], v28, s[8:11], 0 offen offset:0
    s_or_b64 vcc, s[56:57], s[58:59]
    v_cndmask_b32 v27, v25, v22, vcc
    buffer_load_dwordx4 v[100:103], v27, s[8:11], 0 offen offset:128
    s_or_b64 vcc, s[64:65], s[66:67]
    v_cndmask_b32 v29, v25, v23, vcc
    buffer_load_dwordx4 v[108:111], v29, s[8:11], 0 offen offset:128
    v_max_i32 v16, v16, v17
    v_or_b32 v17, v6, v7
    v_cmp_lt_i32 s[70:71], 32, v16
    v_cmp_gt_i32 s[72:73], 0, v17
    v_mov_b32 v24, 1024
    v_mov_b32 v16, 1
    s_cmp_eq_u64 s[70:71], 0
    s_cbranch_scc1 B_nomore
    ds_write_b32 v24, v16
B_nomore:
    s_cmp_lg_u32 s86, 0
    s_cbranch_scc1 B_rk0
    v_mov_b32 v20, 0
    v_mov_b32 v21, 0
    v_mov_b32 v22, 0
    v_mov_b32 v23, 0
    v_add_u32 v13, 83808, v12
    ds_write_b128 v13, v[20:23] offset:0
    ds_write_b128 v13, v[20:23] offset:16384
    ds_write_b128 v13, v[20:23] offset:32768
    v_cmp_gt_u32 vcc, 456, v0
    s_and_saveexec_b64 s[68:69], vcc
    ds_write_b128 v13, v[20:23] offset:49152
    s_mov_b64 exec, s[68:69]
    v_lshrrev_b32 v45, 3, v1
    v_and_b32 v46, 7, v1
    v_xor_b32 v47, v46, v45
    v_lshlrev_b32 v47, 4, v47
    v_lshl_add_u32 v47, v45, 7, v47
    s_add_u32 s51, s40, 140832
    v_add_u32 v47, s51, v47
    v_lshlrev_b32 v45, 1, v2
    v_add_u32 v45, 162336, v45
    ds_read_b128 v[68:71], v45
    ds_read_b128 v[72:75], v45 offset:16
B_rk0:
    v_mov_b32 v44, 8
    s_waitcnt vmcnt(3)
    s_mov_b64 exec, s[52:53]
    v_lshrrev_b32 v112, 16, v97
    ds_add_rtn_u32 v36, v112, v44 offset:0
    s_mov_b64 exec, s[54:55]
    v_lshrrev_b32 v113, 16, v99
    ds_add_rtn_u32 v37, v113, v44 offset:0
    s_waitcnt vmcnt(2)
    s_mov_b64 exec, s[60:61]
    v_lshrrev_b32 v116, 16, v105
    ds_add_rtn_u32 v40, v116, v44 offset:0
    s_mov_b64 exec, s[62:63]
    v_lshrrev_b32 v117, 16, v107
    ds_add_rtn_u32 v41, v117, v44 offset:0
    s_waitcnt vmcnt(1)
    s_mov_b64 exec, s[56:57]
    s_cbranch_execz B_sk1
    v_lshrrev_b32 v114, 16, v101
    ds_add_rtn_u32 v38, v114, v44 offset:0
B_sk1:
    s_mov_b64 exec, s[58:59]
    s_cbranch_execz B_sk2
    v_lshrrev_b32 v115, 16, v103
    ds_add_rtn_u32 v39, v115, v44 offset:0
B_sk2:
    s_waitcnt vmcnt(0)
    s_mov_b64 exec, s[64:65]
    s_cbranch_execz B_sk3
    v_lshrrev_b32 v118, 16, v109
    ds_add_rtn_u32 v42, v118, v44 offset:0
B_sk3:
    s_mov_b64 exec, s[66:67]
    s_cbranch_execz B_sk4
    v_lshrrev_b32 v119, 16, v111
    ds_add_rtn_u32 v43, v119, v44 offset:0
B_sk4:
    s_mov_b64 exec, -1
    s_cmp_lg_u32 s86, 0
    s_cbranch_scc1 B_rkdone
    s_cmp_ge_u32 s3, 8
    s_cbranch_scc1 B_rkdone
    buffer_load_dwordx4 v[32:35], v11, s[16:19], s39 offen
    s_add_u32 s51, s39, 8192
    buffer_load_dwordx4 v[52:55], v11, s[16:19], s51 offen
    s_add_u32 m0, s40, 154144
    s_nop 0
    buffer_load_dwordx4 v11, s[20:23], s40 offen lds
    buffer_load_dwordx4 v[48:51], v11, s[28:31], s40 offen
B_rkdone:
    s_cmp_eq_u64 s[72:73], 0
    s_cbranch_scc1 B_noflag
    ds_write_b32 v24, v16 offset:4
B_noflag:
    s_movk_i32 s51, 504
    s_waitcnt lgkmcnt(0)
    s_mov_b64 exec, s[52:53]
    v_min_u32 v36, s51, v36
    v_mad_u32_u24 v36, v112, s43, v36
    ds_write_b64 v36, v[96:97] offset:3488
    s_mov_b64 exec, s[54:55]
    v_min_u32 v37, s51, v37
    v_mad_u32_u24 v37, v113, s43, v37
    ds_write_b64 v37, v[98:99] offset:3488
    s_mov_b64 exec, s[60:61]
    v_min_u32 v40, s51, v40
    v_mad_u32_u24 v40, v116, s43, v40
    ds_write_b64 v40, v[104:105] offset:3488
    s_mov_b64 exec, s[62:63]
    v_min_u32 v41, s51, v41
    v_mad_u32_u24 v41, v117, s43, v41
    ds_write_b64 v41, v[106:107] offset:3488
    s_mov_b64 exec, s[56:57]
    s_cbranch_execz B_sk5
    v_min_u32 v38, s51, v38
    v_mad_u32_u24 v38, v114, s43, v38
    ds_write_b64 v38, v[100:101] offset:3488
B_sk5:
    s_mov_b64 exec, s[58:59]
    s_cbranch_execz B_sk6
    v_min_u32 v39, s51, v39
    v_mad_u32_u24 v39, v115, s43, v39
    ds_write_b64 v39, v[102:103] offset:3488
B_sk6:
    s_mov_b64 exec, s[64:65]
    s_cbranch_execz B_sk7
    v_min_u32 v42, s51, v42
    v_mad_u32_u24 v42, v118, s43, v42
    ds_write_b64 v42, v[108:109] offset:3488
B_sk7:
    s_mov_b64 exec, s[66:67]
    s_cbranch_execz B_sk8
    v_min_u32 v43, s51, v43
    v_mad_u32_u24 v43, v119, s43, v43
    ds_write_b64 v43, v[110:111] offset:3488
B_sk8:
    s_mov_b64 exec, -1
    s_cmp_lg_u32 s86, 0
    s_cbranch_scc1 B_nxw
    s_cmp_ge_u32 s3, 8
    s_cbranch_scc1 B_nxw
    s_waitcnt vmcnt(0)
    ds_write_b128 v47, v[32:35]
    s_cmp_ge_u32 s3, 5
    s_cbranch_scc1 B_nxw
    ds_write_b128 v47, v[52:55] offset:8192
    v_or3_b32 v48, v48, v49, v50
    v_or_b32 v48, v48, v51
    v_cmp_ne_u32 vcc, 0, v48
    s_nop 1
    s_cbranch_vccz B_nxw
    ds_write_b32 v24, v16 offset:4
B_nxw:
    v_lshrrev_b32 v13, 3, v1
    v_lshlrev_b32 v13, 1, v13
    v_mov_b32 v14, 1040
    v_mov_b32 v15, 1
    v_xor_b32 v46, v46, v9
    v_lshlrev_b32 v45, 7, v8
    v_add_u32 v45, 140832, v45
    v_xor_b32 v47, 0, v46
    v_lshl_add_u32 v92, v47, 4, v45
    v_xor_b32 v47, 2, v46
    v_lshl_add_u32 v93, v47, 4, v45
    v_xor_b32 v47, 4, v46
    v_lshl_add_u32 v94, v47, 4, v45
    v_xor_b32 v47, 6, v46
    v_lshl_add_u32 v95, v47, 4, v45
    s_add_u32 s68, s41, 154144
    v_add_u32 v126, s68, v11
    s_movk_i32 s68, 288
    v_mul_u32_u24 v124, s68, v8
    v_lshl_add_u32 v124, v9, 6, v124
    s_lshl_b32 s68, s34, 5
    v_add_u32 v124, s68, v124
    v_mov_b32 v125, 98
    v_cmp_gt_u32 s[74:75], v125, v8
    s_lshl_b32 s51, s3, 6
    v_lshl_add_u32 v120, v13, 2, s51
    v_mul_u32_u24 v123, s43, v120
    v_mov_b32 v122, 0x31061a8
    s_waitcnt lgkmcnt(0)
    s_barrier
    s_cmp_ge_u32 s3, 12
    s_cbranch_scc1 B_ne0
    ds_read_b32 v121, v120 offset:0
    ds_read_b128 v[56:59], v123 offset:3488
    ds_read_b128 v[60:63], v123 offset:3504
B_ne0:
    s_cmp_lg_u32 s86, 0
    s_cbranch_scc1 B_now3
    s_cmp_lt_u32 s3, 8
    s_cbranch_scc1 B_now3
    s_mov_b32 s86, 1
    ds_read_b128 v[76:79], v92
    ds_read_b128 v[96:99], v126 offset:0
    ds_read_b128 v[80:83], v93
    ds_read_b128 v[100:103], v126 offset:1024
    ds_read_b128 v[84:87], v94
    ds_read_b128 v[104:107], v126 offset:2048
    ds_read_b128 v[88:91], v95
    ds_read_b128 v[108:111], v126 offset:3072
    s_waitcnt lgkmcnt(6)
    v_mfma_f32_32x32x16_bf16 v[16:31], v[96:99], v[76:79], 0
    s_waitcnt lgkmcnt(4)
    v_mfma_f32_32x32x16_bf16 v[16:31], v[100:103], v[80:83], v[16:31]
    s_waitcnt lgkmcnt(2)
    v_mfma_f32_32x32x16_bf16 v[16:31], v[104:107], v[84:87], v[16:31]
    s_waitcnt lgkmcnt(0)
    v_mfma_f32_32x32x16_bf16 v[16:31], v[108:111], v[88:91], v[16:31]
    s_cmp_ge_u32 s3, 12
    s_cbranch_scc1 B_g13
    v_cmp_le_u32 vcc, 64, v121
    ds_read_b128 v[112:115], v123 offset:3520
    ds_read_b128 v[116:119], v123 offset:3536
    v_cndmask_b32 v57, v122, v57, vcc
B_g13:
    s_nop 11
    v_pk_mul_f32 v[16:17], v[16:17], s[94:95]
    v_pk_mul_f32 v[18:19], v[18:19], s[94:95]
    v_pk_mul_f32 v[20:21], v[20:21], s[94:95]
    v_pk_mul_f32 v[22:23], v[22:23], s[94:95]
    v_pk_mul_f32 v[24:25], v[24:25], s[94:95]
    v_pk_mul_f32 v[26:27], v[26:27], s[94:95]
    v_pk_mul_f32 v[28:29], v[28:29], s[94:95]
    v_pk_mul_f32 v[30:31], v[30:31], s[94:95]
    s_mov_b64 exec, s[74:75]
    ds_write_b128 v124, v[16:19] offset:55296
    ds_write_b128 v124, v[20:23] offset:55424
    ds_write_b128 v124, v[24:27] offset:55312
    ds_write_b128 v124, v[28:31] offset:55440
    v_max_f32 v125, |v16|, |v17|
    v_max3_f32 v125, v125, |v18|, |v19|
    v_max3_f32 v125, v125, |v20|, |v21|
    v_max3_f32 v125, v125, |v22|, |v23|
    v_max3_f32 v125, v125, |v24|, |v25|
    v_max3_f32 v125, v125, |v26|, |v27|
    v_max3_f32 v125, v125, |v28|, |v29|
    v_max3_f32 v125, v125, |v30|, |v31|
    v_cmp_lt_f32 vcc, 0x40400000, v125
    s_mov_b64 exec, -1
    v_mov_b32 v125, 1028
    v_mov_b32 v126, 1
    s_cbranch_vccz B_lsd
    ds_write_b32 v125, v126
    s_branch B_lsd
B_now3:
    s_cmp_lt_u32 s3, 8
    s_cbranch_scc1 B_l8
    s_cmp_ge_u32 s3, 12
    s_cbranch_scc1 B_lsd
    s_waitcnt lgkmcnt(0)
    v_cmp_le_u32 vcc, 64, v121
    ds_read_b128 v[112:115], v123 offset:3520
    ds_read_b128 v[116:119], v123 offset:3536
    v_cndmask_b32 v57, v122, v57, vcc
    s_branch B_lsd
B_l8:
    ds_read_b128 v[16:19], v11 offset:0
    s_mov_b32 s86, 1
    v_mul_u32_u24 v20, 1056, v1
    v_add_u32 v21, 528, v20
    s_lshl_b32 s51, s3, 6
    v_add_u32 v28, s51, v20
    v_add_u32 v29, s51, v21
    s_add_u32 s51, s51, 64
    v_mov_b32 v24, 1032
    s_waitcnt lgkmcnt(0)
    v_cmp_le_u32 s[68:69], s51, v16
    v_cmp_le_u32 s[70:71], s51, v18
    s_cmp_lg_u32 s3, 0
    s_cbranch_scc1 B_l8c
    s_mov_b32 s68, 0
    s_mov_b32 s70, 0
    s_and_b32 s69, s69, 0xffff0000
    s_and_b32 s71, s71, 0xffff0000
B_l8c:
    s_bcnt1_i32_b64 s72, s[68:69]
    s_bcnt1_i32_b64 s73, s[70:71]
    s_add_u32 s73, s73, s72
    v_mov_b32 v25, s73
    s_mov_b64 exec, 1
    ds_add_rtn_u32 v26, v24, v25
    s_mov_b64 exec, -1
    v_mbcnt_lo_u32_b32 v22, s68, 0
    v_mbcnt_hi_u32_b32 v22, s69, v22
    v_mbcnt_lo_u32_b32 v23, s70, 0
    v_mbcnt_hi_u32_b32 v23, s71, v23
    v_add_u32 v23, s72, v23
    v_cmp_le_u32 vcc, 64, v121
    ds_read_b128 v[112:115], v123 offset:3520
    ds_read_b128 v[116:119], v123 offset:3536
    v_cndmask_b32 v57, v122, v57, vcc
    s_cmp_lt_u32 s3, 4
    s_cbranch_scc1 B_neg1
    v_mad_u32_u16 v120, v57, s42, v2
    buffer_load_dwordx4 v[32:35], v120, s[12:15], 0 offen
    v_mad_u32_u16 v121, v59, s42, v2
    buffer_load_dwordx4 v[36:39], v121, s[12:15], 0 offen
    v_mad_u32_u16 v120, v61, s42, v2
    buffer_load_dwordx4 v[40:43], v120, s[12:15], 0 offen
    v_mad_u32_u16 v121, v63, s42, v2
    buffer_load_dwordx4 v[44:47], v121, s[12:15], 0 offen
B_neg1:
    s_waitcnt lgkmcnt(2)
    v_readfirstlane_b32 s72, v26
    s_nop 1
    v_add_lshl_u32 v22, v22, s72, 1
    v_add_lshl_u32 v23, v23, s72, 1
    s_mov_b64 exec, s[68:69]
    ds_write_b16 v22, v28 offset:1056
    s_mov_b64 exec, s[70:71]
    ds_write_b16 v23, v29 offset:1056
    s_mov_b64 exec, -1
    s_cmp_ge_u32 s3, 4
    s_cbranch_scc1 B_lsd
B_cls:
    v_bfe_u32 v82, v16, 5, 1
    v_bfe_u32 v84, v16, 3, 2
    v_bfe_u32 v83, v18, 5, 1
    v_bfe_u32 v85, v18, 3, 2
    v_cmp_ne_u32 s[52:53], 0, v82
    v_cmp_eq_u32 s[56:57], 3, v84
    v_cmp_eq_u32 s[60:61], 2, v84
    v_cmp_eq_u32 s[64:65], 1, v84
    v_cmp_ne_u32 s[54:55], 0, v83
    v_cmp_eq_u32 s[58:59], 3, v85
    v_cmp_eq_u32 s[62:63], 2, v85
    v_cmp_eq_u32 s[66:67], 1, v85
    v_max_u32 v86, v16, v18
    v_cmp_lt_u32 vcc, 512, v86
    s_mov_b32 s72, 0
    s_mov_b32 s73, 0
    s_cmp_eq_u32 s3, 0
    s_cselect_b64 s[68:69], s[52:53], s[68:69]
    s_cselect_b64 s[70:71], s[54:55], s[70:71]
    s_cselect_b32 s74, s72, s74
    s_bcnt1_i32_b64 s75, s[52:53]
    s_bcnt1_i32_b64 s76, s[54:55]
    s_add_u32 s75, s75, s76
    s_add_u32 s75, s75, 7
    s_lshr_b32 s75, s75, 3
    s_add_u32 s72, s72, s75
    s_lshl_b32 s75, s72, 0
    s_or_b32 s73, s73, s75
    s_cmp_eq_u32 s3, 1
    s_cselect_b64 s[68:69], s[56:57], s[68:69]
    s_cselect_b64 s[70:71], s[58:59], s[70:71]
    s_cselect_b32 s74, s72, s74
    s_bcnt1_i32_b64 s75, s[56:57]
    s_bcnt1_i32_b64 s76, s[58:59]
    s_add_u32 s75, s75, s76
    s_add_u32 s75, s75, 7
    s_lshr_b32 s75, s75, 3
    s_add_u32 s72, s72, s75
    s_lshl_b32 s75, s72, 8
    s_or_b32 s73, s73, s75
    s_cmp_eq_u32 s3, 2
    s_cselect_b64 s[68:69], s[60:61], s[68:69]
    s_cselect_b64 s[70:71], s[62:63], s[70:71]
    s_cselect_b32 s74, s72, s74
    s_bcnt1_i32_b64 s75, s[60:61]
    s_bcnt1_i32_b64 s76, s[62:63]
    s_add_u32 s75, s75, s76
    s_add_u32 s75, s75, 7
    s_lshr_b32 s75, s75, 3
    s_add_u32 s72, s72, s75
    s_lshl_b32 s75, s72, 16
    s_or_b32 s73, s73, s75
    s_cmp_eq_u32 s3, 3
    s_cselect_b64 s[68:69], s[64:65], s[68:69]
    s_cselect_b64 s[70:71], s[66:67], s[70:71]
    s_cselect_b32 s74, s72, s74
    s_bcnt1_i32_b64 s75, s[64:65]
    s_bcnt1_i32_b64 s76, s[66:67]
    s_add_u32 s75, s75, s76
    s_add_u32 s75, s75, 7
    s_lshr_b32 s75, s75, 3
    s_add_u32 s72, s72, s75
    s_lshl_b32 s75, s72, 24
    s_or_b32 s73, s73, s75
    s_cmp_eq_u32 s3, 0
    s_cselect_b32 s51, 63, 31
    s_not_b32 s51, s51
    s_lshl_b32 s74, s74, 3
    s_bcnt1_i32_b64 s75, s[68:69]
    s_add_u32 s75, s75, s74
    v_and_b32 v16, s51, v16
    v_and_b32 v18, s51, v18
    v_add_u32 v20, v20, v16
    v_add_u32 v21, v21, v18
    v_mbcnt_lo_u32_b32 v82, s68, 0
    v_mbcnt_hi_u32_b32 v82, s69, v82
    v_mbcnt_lo_u32_b32 v83, s70, 0
    v_mbcnt_hi_u32_b32 v83, s71, v83
    v_add_lshl_u32 v82, v82, s74, 1
    v_add_lshl_u32 v83, v83, s75, 1
    s_mov_b64 exec, s[68:69]
    ds_write_b16 v82, v20 offset:2656
    s_mov_b64 exec, s[70:71]
    ds_write_b16 v83, v21 offset:2656
    s_mov_b64 exec, 1
    s_cmp_lg_u64 vcc, 0
    s_cselect_b32 s73, -1, s73
    v_mov_b32 v84, 1036
    v_mov_b32 v85, s73
    ds_write_b32 v84, v85
    s_mov_b64 exec, -1
B_lsd:
    s_waitcnt lgkmcnt(0)
    s_barrier
    s_cmp_lg_u32 s85, -1
    s_cbranch_scc0 B_nowu
    s_mov_b32 s85, -1
    s_cmp_lt_u32 s3, 12
    s_cbranch_scc1 B_nowu
    s_sub_u32 s51, s3, 12
    s_lshl_b32 s51, s51, 11
    s_add_u32 m0, s51, 154144
    s_add_u32 s51, s51, 16384
    buffer_load_dwordx4 v11, s[20:23], s51 offen lds
    buffer_load_dwordx4 v11, s[20:23], s51 offen offset:1024 lds
B_nowu:
    v_mov_b32 v24, 1024
    ds_read_b128 v[16:19], v24
    s_mov_b32 s76, s3
    s_add_u32 s77, s3, 4
    s_cmp_lt_u32 s3, 12
    s_cselect_b32 s77, s3, s77
    s_cbranch_scc1 B_e1
    s_lshl_b32 s51, s76, 4
    v_add_u32 v108, s51, v13
    ds_read_u16 v111, v108 offset:1056
    s_branch B_e2
B_e1:
    s_sub_u32 s51, s3, 4
    s_cmp_lt_u32 s51, 4
    s_cbranch_scc1 B_e1b
    v_mad_u32_u16 v120, v57, s42, v2
    buffer_load_dwordx4 v[32:35], v120, s[12:15], 0 offen
    v_mad_u32_u16 v121, v59, s42, v2
    buffer_load_dwordx4 v[36:39], v121, s[12:15], 0 offen
    v_mad_u32_u16 v120, v61, s42, v2
    buffer_load_dwordx4 v[40:43], v120, s[12:15], 0 offen
    v_mad_u32_u16 v121, v63, s42, v2
    buffer_load_dwordx4 v[44:47], v121, s[12:15], 0 offen
B_e1b:
    v_mad_u32_u16 v110, v57, 36, v2 op_sel:[1,0,0,0]
    ds_read_b128 v[48:51], v110 offset:55296
    ds_read_b128 v[52:55], v110 offset:55424
    v_mad_u32_u16 v67, v57, s84, v3 op_sel:[1,0,0,0]
B_e2:
    s_mov_b64 exec, 1
    ds_add_rtn_u32 v64, v14, v15
    s_mov_b64 exec, -1
    s_mov_b32 s83, 0
    s_setprio 3
    s_waitcnt lgkmcnt(0)
    s_cmp_lt_u32 s3, 12
    s_cbranch_scc1 B_e3
    ds_read_b128 v[56:59], v111 offset:3488
    ds_read_b128 v[60:63], v111 offset:3504
    ds_read_b128 v[112:115], v111 offset:3520
    ds_read_b128 v[116:119], v111 offset:3536
B_e3:
    v_readfirstlane_b32 s70, v19
    v_readfirstlane_b32 s74, v18
    v_readfirstlane_b32 s71, v16
    v_readfirstlane_b32 s91, v17
    s_cmp_lg_u32 s70, -1
    s_cbranch_scc1 B_capok
    s_mov_b32 s87, 0
    s_setprio 0
    s_waitcnt vmcnt(0) lgkmcnt(0)
    s_barrier
    s_branch B_batch
B_capok:
    s_or_b32 s90, s90, s91
    s_add_u32 s74, s74, 7
    s_lshr_b32 s74, s74, 3
    s_and_b32 s72, s70, 0xff
    s_add_u32 s72, s72, s74
    s_bfe_u32 s73, s70, 0x80008
    s_add_u32 s73, s73, s74
    s_bfe_u32 s82, s70, 0x80010
    s_add_u32 s82, s82, s74
    s_lshr_b32 s75, s70, 24
    s_add_u32 s75, s75, s74
    s_cmp_lt_u32 s3, 12
    s_cbranch_scc1 B_e4
    s_cmp_ge_u32 s76, s75
    s_cbranch_scc1 B_loop_end
    s_cmp_ge_u32 s76, s74
    s_cbranch_scc1 B_pre4
    s_waitcnt lgkmcnt(0)
    v_mad_u32_u16 v108, v57, s42, v2
    buffer_load_dwordx4 v[32:35], v108, s[12:15], 0 offen
    v_mad_u32_u16 v109, v59, s42, v2
    buffer_load_dwordx4 v[36:39], v109, s[12:15], 0 offen
    v_mad_u32_u16 v108, v61, s42, v2
    buffer_load_dwordx4 v[40:43], v108, s[12:15], 0 offen
    v_mad_u32_u16 v109, v63, s42, v2
    buffer_load_dwordx4 v[44:47], v109, s[12:15], 0 offen
    v_mad_u32_u16 v110, v57, 36, v2 op_sel:[1,0,0,0]
    ds_read_b128 v[48:51], v110 offset:55296
    ds_read_b128 v[52:55], v110 offset:55424
    v_mad_u32_u16 v67, v57, s84, v3 op_sel:[1,0,0,0]
B_e4:
    s_cmp_ge_u32 s77, s74
    s_cbranch_scc1 B_rrP0
    s_lshl_b32 s51, s77, 4
    v_add_u32 v108, s51, v13
    ds_read_u16 v111, v108 offset:1056
    s_branch B_rrX0
B_rrP0:
    s_sub_u32 s79, s77, s74
    s_min_u32 s79, s79, 51
    s_lshl_b32 s51, s79, 4
    v_add_u32 v108, s51, v13
    ds_read_u16 v111, v108 offset:2656
B_rrX0:
    s_waitcnt lgkmcnt(0)
    s_cmp_lg_u32 s90, 0
    s_cbranch_scc1 B_loop8p
B_loop8:
    s_waitcnt lgkmcnt(8)
    v_mov_b32 v66, v67
    v_readfirstlane_b32 s78, v64
    v_pk_fma_f32 v[76:77], v[56:57], v[68:69], v[48:49] op_sel_hi:[0,1,1]
    v_pk_fma_f32 v[78:79], v[56:57], v[70:71], v[50:51] op_sel_hi:[0,1,1]
    v_pk_fma_f32 v[80:81], v[56:57], v[72:73], v[52:53] op_sel_hi:[0,1,1]
    v_pk_fma_f32 v[82:83], v[56:57], v[74:75], v[54:55] op_sel_hi:[0,1,1]
    v_pk_fma_f32 v[84:85], v[58:59], v[68:69], v[48:49] op_sel_hi:[0,1,1]
    v_pk_fma_f32 v[86:87], v[58:59], v[70:71], v[50:51] op_sel_hi:[0,1,1]
    v_pk_fma_f32 v[88:89], v[58:59], v[72:73], v[52:53] op_sel_hi:[0,1,1]
    v_pk_fma_f32 v[90:91], v[58:59], v[74:75], v[54:55] op_sel_hi:[0,1,1]
    v_pk_fma_f32 v[92:93], v[60:61], v[68:69], v[48:49] op_sel_hi:[0,1,1]
    v_pk_fma_f32 v[94:95], v[60:61], v[70:71], v[50:51] op_sel_hi:[0,1,1]
    v_pk_fma_f32 v[96:97], v[60:61], v[72:73], v[52:53] op_sel_hi:[0,1,1]
    v_pk_fma_f32 v[98:99], v[60:61], v[74:75], v[54:55] op_sel_hi:[0,1,1]
    v_pk_fma_f32 v[100:101], v[62:63], v[68:69], v[48:49] op_sel_hi:[0,1,1]
    v_pk_fma_f32 v[102:103], v[62:63], v[70:71], v[50:51] op_sel_hi:[0,1,1]
    v_pk_fma_f32 v[104:105], v[62:63], v[72:73], v[52:53] op_sel_hi:[0,1,1]
    v_pk_fma_f32 v[106:107], v[62:63], v[74:75], v[54:55] op_sel_hi:[0,1,1]
    ds_read_b128 v[56:59], v111 offset:3488
    ds_read_b128 v[60:63], v111 offset:3504
    s_add_u32 s78, s78, 20
    s_waitcnt vmcnt(3)
    v_dot2_f32_bf16 v80, v32, s46, v80
    v_dot2_f32_bf16 v81, v33, s46, v81
    v_dot2_f32_bf16 v82, v34, s46, v82
    v_dot2_f32_bf16 v83, v35, s46, v83
    v_pk_add_f32 v[76:77], v[32:33], v[76:77]
    v_pk_add_f32 v[78:79], v[34:35], v[78:79]
    v_mad_u32_u16 v108, v113, s42, v2
    buffer_load_dwordx4 v[32:35], v108, s[12:15], 0 offen
    v_exp_f32 v4, v76
    v_exp_f32 v5, v77
    v_exp_f32 v6, v78
    v_exp_f32 v7, v79
    v_exp_f32 v8, v80
    v_exp_f32 v9, v81
    v_exp_f32 v10, v82
    v_exp_f32 v11, v83
    v_pk_add_f32 v[4:5], v[4:5], s[44:45]
    v_pk_add_f32 v[6:7], v[6:7], s[44:45]
    v_pk_add_f32 v[8:9], v[8:9], s[44:45]
    v_pk_add_f32 v[10:11], v[10:11], s[44:45]
    s_waitcnt vmcnt(3)
    v_dot2_f32_bf16 v88, v36, s46, v88
    v_dot2_f32_bf16 v89, v37, s46, v89
    v_dot2_f32_bf16 v90, v38, s46, v90
    v_dot2_f32_bf16 v91, v39, s46, v91
    v_pk_add_f32 v[84:85], v[36:37], v[84:85]
    v_pk_add_f32 v[86:87], v[38:39], v[86:87]
    v_mad_u32_u16 v109, v115, s42, v2
    buffer_load_dwordx4 v[36:39], v109, s[12:15], 0 offen
    v_exp_f32 v16, v84
    v_exp_f32 v17, v85
    v_exp_f32 v18, v86
    v_exp_f32 v19, v87
    v_exp_f32 v20, v88
    v_exp_f32 v21, v89
    v_exp_f32 v22, v90
    v_exp_f32 v23, v91
    v_pk_fma_f32 v[84:85], v[84:85], v[4:5], v[76:77]
    v_pk_fma_f32 v[86:87], v[86:87], v[6:7], v[78:79]
    v_pk_fma_f32 v[88:89], v[88:89], v[8:9], v[80:81]
    v_pk_fma_f32 v[90:91], v[90:91], v[10:11], v[82:83]
    v_pk_fma_f32 v[120:121], v[76:77], v[16:17], v[84:85]
    v_pk_fma_f32 v[122:123], v[78:79], v[18:19], v[86:87]
    v_pk_fma_f32 v[124:125], v[80:81], v[20:21], v[88:89]
    v_pk_fma_f32 v[126:127], v[82:83], v[22:23], v[90:91]
    v_pk_fma_f32 v[4:5], v[4:5], v[16:17], v[4:5]
    v_pk_fma_f32 v[6:7], v[6:7], v[18:19], v[6:7]
    v_pk_fma_f32 v[8:9], v[8:9], v[20:21], v[8:9]
    v_pk_fma_f32 v[10:11], v[10:11], v[22:23], v[10:11]
    s_waitcnt vmcnt(3)
    v_dot2_f32_bf16 v96, v40, s46, v96
    v_dot2_f32_bf16 v97, v41, s46, v97
    v_dot2_f32_bf16 v98, v42, s46, v98
    v_dot2_f32_bf16 v99, v43, s46, v99
    v_pk_add_f32 v[92:93], v[40:41], v[92:93]
    v_pk_add_f32 v[94:95], v[42:43], v[94:95]
    v_mad_u32_u16 v108, v117, s42, v2
    buffer_load_dwordx4 v[40:43], v108, s[12:15], 0 offen
    v_exp_f32 v16, v92
    v_exp_f32 v17, v93
    v_exp_f32 v18, v94
    v_exp_f32 v19, v95
    v_exp_f32 v20, v96
    v_exp_f32 v21, v97
    v_exp_f32 v22, v98
    v_exp_f32 v23, v99
    v_pk_fma_f32 v[92:93], v[92:93], v[4:5], v[120:121]
    v_pk_fma_f32 v[94:95], v[94:95], v[6:7], v[122:123]
    v_pk_fma_f32 v[96:97], v[96:97], v[8:9], v[124:125]
    v_pk_fma_f32 v[98:99], v[98:99], v[10:11], v[126:127]
    v_pk_fma_f32 v[120:121], v[120:121], v[16:17], v[92:93]
    v_pk_fma_f32 v[122:123], v[122:123], v[18:19], v[94:95]
    v_pk_fma_f32 v[124:125], v[124:125], v[20:21], v[96:97]
    v_pk_fma_f32 v[126:127], v[126:127], v[22:23], v[98:99]
    v_pk_fma_f32 v[4:5], v[4:5], v[16:17], v[4:5]
    v_pk_fma_f32 v[6:7], v[6:7], v[18:19], v[6:7]
    v_pk_fma_f32 v[8:9], v[8:9], v[20:21], v[8:9]
    v_pk_fma_f32 v[10:11], v[10:11], v[22:23], v[10:11]
    s_waitcnt vmcnt(3)
    v_dot2_f32_bf16 v104, v44, s46, v104
    v_dot2_f32_bf16 v105, v45, s46, v105
    v_dot2_f32_bf16 v106, v46, s46, v106
    v_dot2_f32_bf16 v107, v47, s46, v107
    v_pk_add_f32 v[100:101], v[44:45], v[100:101]
    v_pk_add_f32 v[102:103], v[46:47], v[102:103]
    v_mad_u32_u16 v109, v119, s42, v2
    buffer_load_dwordx4 v[44:47], v109, s[12:15], 0 offen
    v_exp_f32 v16, v100
    v_exp_f32 v17, v101
    v_exp_f32 v18, v102
    v_exp_f32 v19, v103
    v_exp_f32 v20, v104
    v_exp_f32 v21, v105
    v_exp_f32 v22, v106
    v_exp_f32 v23, v107
    v_pk_fma_f32 v[100:101], v[100:101], v[4:5], v[120:121]
    v_pk_fma_f32 v[102:103], v[102:103], v[6:7], v[122:123]
    v_pk_fma_f32 v[104:105], v[104:105], v[8:9], v[124:125]
    v_pk_fma_f32 v[106:107], v[106:107], v[10:11], v[126:127]
    v_pk_fma_f32 v[120:121], v[120:121], v[16:17], v[100:101]
    v_pk_fma_f32 v[122:123], v[122:123], v[18:19], v[102:103]
    v_pk_fma_f32 v[124:125], v[124:125], v[20:21], v[104:105]
    v_pk_fma_f32 v[126:127], v[126:127], v[22:23], v[106:107]
    v_pk_fma_f32 v[4:5], v[4:5], v[16:17], v[4:5]
    v_pk_fma_f32 v[6:7], v[6:7], v[18:19], v[6:7]
    v_pk_fma_f32 v[8:9], v[8:9], v[20:21], v[8:9]
    v_pk_fma_f32 v[10:11], v[10:11], v[22:23], v[10:11]
    v_pk_fma_f32 v[76:77], v[112:113], v[68:69], v[48:49] op_sel_hi:[0,1,1]
    v_pk_fma_f32 v[78:79], v[112:113], v[70:71], v[50:51] op_sel_hi:[0,1,1]
    v_pk_fma_f32 v[80:81], v[112:113], v[72:73], v[52:53] op_sel_hi:[0,1,1]
    v_pk_fma_f32 v[82:83], v[112:113], v[74:75], v[54:55] op_sel_hi:[0,1,1]
    v_pk_fma_f32 v[84:85], v[114:115], v[68:69], v[48:49] op_sel_hi:[0,1,1]
    v_pk_fma_f32 v[86:87], v[114:115], v[70:71], v[50:51] op_sel_hi:[0,1,1]
    v_pk_fma_f32 v[88:89], v[114:115], v[72:73], v[52:53] op_sel_hi:[0,1,1]
    v_pk_fma_f32 v[90:91], v[114:115], v[74:75], v[54:55] op_sel_hi:[0,1,1]
    v_pk_fma_f32 v[92:93], v[116:117], v[68:69], v[48:49] op_sel_hi:[0,1,1]
    v_pk_fma_f32 v[94:95], v[116:117], v[70:71], v[50:51] op_sel_hi:[0,1,1]
    v_pk_fma_f32 v[96:97], v[116:117], v[72:73], v[52:53] op_sel_hi:[0,1,1]
    v_pk_fma_f32 v[98:99], v[116:117], v[74:75], v[54:55] op_sel_hi:[0,1,1]
    v_pk_fma_f32 v[100:101], v[118:119], v[68:69], v[48:49] op_sel_hi:[0,1,1]
    v_pk_fma_f32 v[102:103], v[118:119], v[70:71], v[50:51] op_sel_hi:[0,1,1]
    v_pk_fma_f32 v[104:105], v[118:119], v[72:73], v[52:53] op_sel_hi:[0,1,1]
    v_pk_fma_f32 v[106:107], v[118:119], v[74:75], v[54:55] op_sel_hi:[0,1,1]
    s_waitcnt lgkmcnt(0)
    v_mad_u32_u16 v110, v57, 36, v2 op_sel:[1,0,0,0]
    ds_read_b128 v[48:51], v110 offset:55296
    ds_read_b128 v[52:55], v110 offset:55424
    v_mad_u32_u16 v67, v57, s84, v3 op_sel:[1,0,0,0]
    s_cmp_ge_u32 s77, s74
    s_cbranch_scc1 B_tr8
    ds_read_b128 v[112:115], v111 offset:3520
    ds_read_b128 v[116:119], v111 offset:3536
    s_cmp_ge_u32 s78, s74
    s_cbranch_scc1 B_rrP1
    s_lshl_b32 s51, s78, 4
    v_add_u32 v108, s51, v13
    ds_read_u16 v111, v108 offset:1056
    s_branch B_rrX1
B_rrP1:
    s_sub_u32 s79, s78, s74
    s_min_u32 s79, s79, 51
    s_lshl_b32 s51, s79, 4
    v_add_u32 v108, s51, v13
    ds_read_u16 v111, v108 offset:2656
B_rrX1:
    s_branch B_tr8x
B_tr8:
    s_sub_u32 s79, s78, s74
    s_min_u32 s79, s79, 51
    s_lshl_b32 s51, s79, 4
    v_add_u32 v108, s51, v13
    ds_read_u16 v111, v108 offset:2656
    s_waitcnt lgkmcnt(0)
    ds_read_b128 v[112:115], v111 offset:3488
    ds_read_b128 v[116:119], v111 offset:3504
B_tr8x:
    s_mov_b64 exec, 1
    ds_add_rtn_u32 v64, v14, v15
    s_mov_b64 exec, -1
    s_waitcnt vmcnt(3)
    v_dot2_f32_bf16 v80, v32, s46, v80
    v_dot2_f32_bf16 v81, v33, s46, v81
    v_dot2_f32_bf16 v82, v34, s46, v82
    v_dot2_f32_bf16 v83, v35, s46, v83
    v_pk_add_f32 v[76:77], v[32:33], v[76:77]
    v_pk_add_f32 v[78:79], v[34:35], v[78:79]
    v_mad_u32_u16 v108, v57, s42, v2
    buffer_load_dwordx4 v[32:35], v108, s[12:15], 0 offen
    v_exp_f32 v16, v76
    v_exp_f32 v17, v77
    v_exp_f32 v18, v78
    v_exp_f32 v19, v79
    v_exp_f32 v20, v80
    v_exp_f32 v21, v81
    v_exp_f32 v22, v82
    v_exp_f32 v23, v83
    v_pk_fma_f32 v[76:77], v[76:77], v[4:5], v[120:121]
    v_pk_fma_f32 v[78:79], v[78:79], v[6:7], v[122:123]
    v_pk_fma_f32 v[80:81], v[80:81], v[8:9], v[124:125]
    v_pk_fma_f32 v[82:83], v[82:83], v[10:11], v[126:127]
    v_pk_fma_f32 v[120:121], v[120:121], v[16:17], v[76:77]
    v_pk_fma_f32 v[122:123], v[122:123], v[18:19], v[78:79]
    v_pk_fma_f32 v[124:125], v[124:125], v[20:21], v[80:81]
    v_pk_fma_f32 v[126:127], v[126:127], v[22:23], v[82:83]
    v_pk_fma_f32 v[4:5], v[4:5], v[16:17], v[4:5]
    v_pk_fma_f32 v[6:7], v[6:7], v[18:19], v[6:7]
    v_pk_fma_f32 v[8:9], v[8:9], v[20:21], v[8:9]
    v_pk_fma_f32 v[10:11], v[10:11], v[22:23], v[10:11]
    s_waitcnt vmcnt(3)
    v_dot2_f32_bf16 v88, v36, s46, v88
    v_dot2_f32_bf16 v89, v37, s46, v89
    v_dot2_f32_bf16 v90, v38, s46, v90
    v_dot2_f32_bf16 v91, v39, s46, v91
    v_pk_add_f32 v[84:85], v[36:37], v[84:85]
    v_pk_add_f32 v[86:87], v[38:39], v[86:87]
    v_mad_u32_u16 v109, v59, s42, v2
    buffer_load_dwordx4 v[36:39], v109, s[12:15], 0 offen
    v_exp_f32 v16, v84
    v_exp_f32 v17, v85
    v_exp_f32 v18, v86
    v_exp_f32 v19, v87
    v_exp_f32 v20, v88
    v_exp_f32 v21, v89
    v_exp_f32 v22, v90
    v_exp_f32 v23, v91
    v_pk_fma_f32 v[84:85], v[84:85], v[4:5], v[120:121]
    v_pk_fma_f32 v[86:87], v[86:87], v[6:7], v[122:123]
    v_pk_fma_f32 v[88:89], v[88:89], v[8:9], v[124:125]
    v_pk_fma_f32 v[90:91], v[90:91], v[10:11], v[126:127]
    v_pk_fma_f32 v[120:121], v[120:121], v[16:17], v[84:85]
    v_pk_fma_f32 v[122:123], v[122:123], v[18:19], v[86:87]
    v_pk_fma_f32 v[124:125], v[124:125], v[20:21], v[88:89]
    v_pk_fma_f32 v[126:127], v[126:127], v[22:23], v[90:91]
    v_pk_fma_f32 v[4:5], v[4:5], v[16:17], v[4:5]
    v_pk_fma_f32 v[6:7], v[6:7], v[18:19], v[6:7]
    v_pk_fma_f32 v[8:9], v[8:9], v[20:21], v[8:9]
    v_pk_fma_f32 v[10:11], v[10:11], v[22:23], v[10:11]
    s_waitcnt vmcnt(3)
    v_dot2_f32_bf16 v96, v40, s46, v96
    v_dot2_f32_bf16 v97, v41, s46, v97
    v_dot2_f32_bf16 v98, v42, s46, v98
    v_dot2_f32_bf16 v99, v43, s46, v99
    v_pk_add_f32 v[92:93], v[40:41], v[92:93]
    v_pk_add_f32 v[94:95], v[42:43], v[94:95]
    v_mad_u32_u16 v108, v61, s42, v2
    buffer_load_dwordx4 v[40:43], v108, s[12:15], 0 offen
    v_exp_f32 v16, v92
    v_exp_f32 v17, v93
    v_exp_f32 v18, v94
    v_exp_f32 v19, v95
    v_exp_f32 v20, v96
    v_exp_f32 v21, v97
    v_exp_f32 v22, v98
    v_exp_f32 v23, v99
    v_pk_fma_f32 v[92:93], v[92:93], v[4:5], v[120:121]
    v_pk_fma_f32 v[94:95], v[94:95], v[6:7], v[122:123]
    v_pk_fma_f32 v[96:97], v[96:97], v[8:9], v[124:125]
    v_pk_fma_f32 v[98:99], v[98:99], v[10:11], v[126:127]
    v_pk_fma_f32 v[120:121], v[120:121], v[16:17], v[92:93]
    v_pk_fma_f32 v[122:123], v[122:123], v[18:19], v[94:95]
    v_pk_fma_f32 v[124:125], v[124:125], v[20:21], v[96:97]
    v_pk_fma_f32 v[126:127], v[126:127], v[22:23], v[98:99]
    v_pk_fma_f32 v[4:5], v[4:5], v[16:17], v[4:5]
    v_pk_fma_f32 v[6:7], v[6:7], v[18:19], v[6:7]
    v_pk_fma_f32 v[8:9], v[8:9], v[20:21], v[8:9]
    v_pk_fma_f32 v[10:11], v[10:11], v[22:23], v[10:11]
    s_waitcnt vmcnt(3)
    v_dot2_f32_bf16 v104, v44, s46, v104
    v_dot2_f32_bf16 v105, v45, s46, v105
    v_dot2_f32_bf16 v106, v46, s46, v106
    v_dot2_f32_bf16 v107, v47, s46, v107
    v_pk_add_f32 v[100:101], v[44:45], v[100:101]
    v_pk_add_f32 v[102:103], v[46:47], v[102:103]
    v_mad_u32_u16 v109, v63, s42, v2
    buffer_load_dwordx4 v[44:47], v109, s[12:15], 0 offen
    v_exp_f32 v16, v100
    v_exp_f32 v17, v101
    v_exp_f32 v18, v102
    v_exp_f32 v19, v103
    v_exp_f32 v20, v104
    v_exp_f32 v21, v105
    v_exp_f32 v22, v106
    v_exp_f32 v23, v107
    v_pk_fma_f32 v[100:101], v[100:101], v[4:5], v[120:121]
    v_pk_fma_f32 v[102:103], v[102:103], v[6:7], v[122:123]
    v_pk_fma_f32 v[104:105], v[104:105], v[8:9], v[124:125]
    v_pk_fma_f32 v[106:107], v[106:107], v[10:11], v[126:127]
    v_pk_fma_f32 v[120:121], v[120:121], v[16:17], v[100:101]
    v_pk_fma_f32 v[122:123], v[122:123], v[18:19], v[102:103]
    v_pk_fma_f32 v[124:125], v[124:125], v[20:21], v[104:105]
    v_pk_fma_f32 v[126:127], v[126:127], v[22:23], v[106:107]
    v_pk_fma_f32 v[4:5], v[4:5], v[16:17], v[4:5]
    v_pk_fma_f32 v[6:7], v[6:7], v[18:19], v[6:7]
    v_pk_fma_f32 v[8:9], v[8:9], v[20:21], v[8:9]
    v_pk_fma_f32 v[10:11], v[10:11], v[22:23], v[10:11]
    v_rcp_f32 v4, v4
    v_rcp_f32 v5, v5
    v_rcp_f32 v6, v6
    v_rcp_f32 v7, v7
    v_rcp_f32 v8, v8
    v_rcp_f32 v9, v9
    v_rcp_f32 v10, v10
    v_rcp_f32 v11, v11
    v_pk_mul_f32 v[4:5], v[120:121], v[4:5]
    v_pk_mul_f32 v[6:7], v[122:123], v[6:7]
    v_pk_mul_f32 v[8:9], v[124:125], v[8:9]
    v_pk_mul_f32 v[10:11], v[126:127], v[10:11]
    v_cvt_f64_f32 v[16:17], v4
    v_cvt_f64_f32 v[18:19], v5
    v_cvt_f64_f32 v[20:21], v6
    v_cvt_f64_f32 v[22:23], v7
    v_cvt_f64_f32 v[24:25], v8
    v_cvt_f64_f32 v[26:27], v9
    v_cvt_f64_f32 v[28:29], v10
    v_cvt_f64_f32 v[30:31], v11
    ds_add_f64 v66, v[16:17] offset:0
    ds_add_f64 v66, v[18:19] offset:64
    ds_add_f64 v66, v[20:21] offset:128
    ds_add_f64 v66, v[22:23] offset:192
    ds_add_f64 v66, v[24:25] offset:256
    ds_add_f64 v66, v[26:27] offset:320
    ds_add_f64 v66, v[28:29] offset:384
    ds_add_f64 v66, v[30:31] offset:448
    s_add_u32 s83, s83, 2
    s_cmp_lt_u32 s83, 2
    s_cbranch_scc1 B_pr0
    s_setprio 2
    s_cmp_lt_u32 s83, 6
    s_cbranch_scc1 B_pr0
    s_setprio 1
    s_cmp_lt_u32 s83, 7
    s_cbranch_scc1 B_pr0
    s_setprio 0
B_pr0:
    s_mov_b32 s76, s77
    s_mov_b32 s77, s78
    s_cmp_lt_u32 s76, s74
    s_cbranch_scc1 B_loop8
    s_cmp_lt_u32 s76, s75
    s_cbranch_scc1 B_loop0
    s_branch B_loop_end
B_loop8p:
    s_waitcnt lgkmcnt(8)
    v_mov_b32 v66, v67
    v_readfirstlane_b32 s78, v64
    v_pk_fma_f32 v[76:77], v[56:57], v[68:69], v[48:49] op_sel_hi:[0,1,1]
    v_pk_fma_f32 v[78:79], v[56:57], v[70:71], v[50:51] op_sel_hi:[0,1,1]
    v_pk_fma_f32 v[80:81], v[56:57], v[72:73], v[52:53] op_sel_hi:[0,1,1]
    v_pk_fma_f32 v[82:83], v[56:57], v[74:75], v[54:55] op_sel_hi:[0,1,1]
    v_pk_fma_f32 v[84:85], v[58:59], v[68:69], v[48:49] op_sel_hi:[0,1,1]
    v_pk_fma_f32 v[86:87], v[58:59], v[70:71], v[50:51] op_sel_hi:[0,1,1]
    v_pk_fma_f32 v[88:89], v[58:59], v[72:73], v[52:53] op_sel_hi:[0,1,1]
    v_pk_fma_f32 v[90:91], v[58:59], v[74:75], v[54:55] op_sel_hi:[0,1,1]
    v_pk_fma_f32 v[92:93], v[60:61], v[68:69], v[48:49] op_sel_hi:[0,1,1]
    v_pk_fma_f32 v[94:95], v[60:61], v[70:71], v[50:51] op_sel_hi:[0,1,1]
    v_pk_fma_f32 v[96:97], v[60:61], v[72:73], v[52:53] op_sel_hi:[0,1,1]
    v_pk_fma_f32 v[98:99], v[60:61], v[74:75], v[54:55] op_sel_hi:[0,1,1]
    v_pk_fma_f32 v[100:101], v[62:63], v[68:69], v[48:49] op_sel_hi:[0,1,1]
    v_pk_fma_f32 v[102:103], v[62:63], v[70:71], v[50:51] op_sel_hi:[0,1,1]
    v_pk_fma_f32 v[104:105], v[62:63], v[72:73], v[52:53] op_sel_hi:[0,1,1]
    v_pk_fma_f32 v[106:107], v[62:63], v[74:75], v[54:55] op_sel_hi:[0,1,1]
    ds_read_b128 v[56:59], v111 offset:3488
    ds_read_b128 v[60:63], v111 offset:3504
    s_add_u32 s78, s78, 20
    s_waitcnt vmcnt(3)
    v_dot2_f32_bf16 v80, v32, s46, v80
    v_dot2_f32_bf16 v81, v33, s46, v81
    v_dot2_f32_bf16 v82, v34, s46, v82
    v_dot2_f32_bf16 v83, v35, s46, v83
    v_pk_add_f32 v[76:77], v[32:33], v[76:77]
    v_pk_add_f32 v[78:79], v[34:35], v[78:79]
    v_mad_u32_u16 v108, v113, s42, v2
    buffer_load_dwordx4 v[32:35], v108, s[12:15], 0 offen
    v_exp_f32 v16, v76
    v_exp_f32 v17, v77
    v_exp_f32 v18, v78
    v_exp_f32 v19, v79
    v_exp_f32 v20, v80
    v_exp_f32 v21, v81
    v_exp_f32 v22, v82
    v_exp_f32 v23, v83
    v_pk_add_f32 v[16:17], v[16:17], s[44:45]
    v_pk_add_f32 v[18:19], v[18:19], s[44:45]
    v_pk_add_f32 v[20:21], v[20:21], s[44:45]
    v_pk_add_f32 v[22:23], v[22:23], s[44:45]
    v_rcp_f32 v16, v16
    v_rcp_f32 v17, v17
    v_rcp_f32 v18, v18
    v_rcp_f32 v19, v19
    v_rcp_f32 v20, v20
    v_rcp_f32 v21, v21
    v_rcp_f32 v22, v22
    v_rcp_f32 v23, v23
    v_pk_mul_f32 v[120:121], v[76:77], v[16:17]
    v_pk_mul_f32 v[122:123], v[78:79], v[18:19]
    v_pk_mul_f32 v[124:125], v[80:81], v[20:21]
    v_pk_mul_f32 v[126:127], v[82:83], v[22:23]
    s_waitcnt vmcnt(3)
    v_dot2_f32_bf16 v88, v36, s46, v88
    v_dot2_f32_bf16 v89, v37, s46, v89
    v_dot2_f32_bf16 v90, v38, s46, v90
    v_dot2_f32_bf16 v91, v39, s46, v91
    v_pk_add_f32 v[84:85], v[36:37], v[84:85]
    v_pk_add_f32 v[86:87], v[38:39], v[86:87]
    v_mad_u32_u16 v109, v115, s42, v2
    buffer_load_dwordx4 v[36:39], v109, s[12:15], 0 offen
    v_exp_f32 v16, v84
    v_exp_f32 v17, v85
    v_exp_f32 v18, v86
    v_exp_f32 v19, v87
    v_exp_f32 v20, v88
    v_exp_f32 v21, v89
    v_exp_f32 v22, v90
    v_exp_f32 v23, v91
    v_pk_add_f32 v[16:17], v[16:17], s[44:45]
    v_pk_add_f32 v[18:19], v[18:19], s[44:45]
    v_pk_add_f32 v[20:21], v[20:21], s[44:45]
    v_pk_add_f32 v[22:23], v[22:23], s[44:45]
    v_rcp_f32 v16, v16
    v_rcp_f32 v17, v17
    v_rcp_f32 v18, v18
    v_rcp_f32 v19, v19
    v_rcp_f32 v20, v20
    v_rcp_f32 v21, v21
    v_rcp_f32 v22, v22
    v_rcp_f32 v23, v23
    v_pk_fma_f32 v[120:121], v[84:85], v[16:17], v[120:121]
    v_pk_fma_f32 v[122:123], v[86:87], v[18:19], v[122:123]
    v_pk_fma_f32 v[124:125], v[88:89], v[20:21], v[124:125]
    v_pk_fma_f32 v[126:127], v[90:91], v[22:23], v[126:127]
    s_waitcnt vmcnt(3)
    v_dot2_f32_bf16 v96, v40, s46, v96
    v_dot2_f32_bf16 v97, v41, s46, v97
    v_dot2_f32_bf16 v98, v42, s46, v98
    v_dot2_f32_bf16 v99, v43, s46, v99
    v_pk_add_f32 v[92:93], v[40:41], v[92:93]
    v_pk_add_f32 v[94:95], v[42:43], v[94:95]
    v_mad_u32_u16 v108, v117, s42, v2
    buffer_load_dwordx4 v[40:43], v108, s[12:15], 0 offen
    v_exp_f32 v16, v92
    v_exp_f32 v17, v93
    v_exp_f32 v18, v94
    v_exp_f32 v19, v95
    v_exp_f32 v20, v96
    v_exp_f32 v21, v97
    v_exp_f32 v22, v98
    v_exp_f32 v23, v99
    v_pk_add_f32 v[16:17], v[16:17], s[44:45]
    v_pk_add_f32 v[18:19], v[18:19], s[44:45]
    v_pk_add_f32 v[20:21], v[20:21], s[44:45]
    v_pk_add_f32 v[22:23], v[22:23], s[44:45]
    v_rcp_f32 v16, v16
    v_rcp_f32 v17, v17
    v_rcp_f32 v18, v18
    v_rcp_f32 v19, v19
    v_rcp_f32 v20, v20
    v_rcp_f32 v21, v21
    v_rcp_f32 v22, v22
    v_rcp_f32 v23, v23
    v_pk_fma_f32 v[120:121], v[92:93], v[16:17], v[120:121]
    v_pk_fma_f32 v[122:123], v[94:95], v[18:19], v[122:123]
    v_pk_fma_f32 v[124:125], v[96:97], v[20:21], v[124:125]
    v_pk_fma_f32 v[126:127], v[98:99], v[22:23], v[126:127]
    s_waitcnt vmcnt(3)
    v_dot2_f32_bf16 v104, v44, s46, v104
    v_dot2_f32_bf16 v105, v45, s46, v105
    v_dot2_f32_bf16 v106, v46, s46, v106
    v_dot2_f32_bf16 v107, v47, s46, v107
    v_pk_add_f32 v[100:101], v[44:45], v[100:101]
    v_pk_add_f32 v[102:103], v[46:47], v[102:103]
    v_mad_u32_u16 v109, v119, s42, v2
    buffer_load_dwordx4 v[44:47], v109, s[12:15], 0 offen
    v_exp_f32 v16, v100
    v_exp_f32 v17, v101
    v_exp_f32 v18, v102
    v_exp_f32 v19, v103
    v_exp_f32 v20, v104
    v_exp_f32 v21, v105
    v_exp_f32 v22, v106
    v_exp_f32 v23, v107
    v_pk_add_f32 v[16:17], v[16:17], s[44:45]
    v_pk_add_f32 v[18:19], v[18:19], s[44:45]
    v_pk_add_f32 v[20:21], v[20:21], s[44:45]
    v_pk_add_f32 v[22:23], v[22:23], s[44:45]
    v_rcp_f32 v16, v16
    v_rcp_f32 v17, v17
    v_rcp_f32 v18, v18
    v_rcp_f32 v19, v19
    v_rcp_f32 v20, v20
    v_rcp_f32 v21, v21
    v_rcp_f32 v22, v22
    v_rcp_f32 v23, v23
    v_pk_fma_f32 v[120:121], v[100:101], v[16:17], v[120:121]
    v_pk_fma_f32 v[122:123], v[102:103], v[18:19], v[122:123]
    v_pk_fma_f32 v[124:125], v[104:105], v[20:21], v[124:125]
    v_pk_fma_f32 v[126:127], v[106:107], v[22:23], v[126:127]
    v_pk_fma_f32 v[76:77], v[112:113], v[68:69], v[48:49] op_sel_hi:[0,1,1]
    v_pk_fma_f32 v[78:79], v[112:113], v[70:71], v[50:51] op_sel_hi:[0,1,1]
    v_pk_fma_f32 v[80:81], v[112:113], v[72:73], v[52:53] op_sel_hi:[0,1,1]
    v_pk_fma_f32 v[82:83], v[112:113], v[74:75], v[54:55] op_sel_hi:[0,1,1]
    v_pk_fma_f32 v[84:85], v[114:115], v[68:69], v[48:49] op_sel_hi:[0,1,1]
    v_pk_fma_f32 v[86:87], v[114:115], v[70:71], v[50:51] op_sel_hi:[0,1,1]
    v_pk_fma_f32 v[88:89], v[114:115], v[72:73], v[52:53] op_sel_hi:[0,1,1]
    v_pk_fma_f32 v[90:91], v[114:115], v[74:75], v[54:55] op_sel_hi:[0,1,1]
    v_pk_fma_f32 v[92:93], v[116:117], v[68:69], v[48:49] op_sel_hi:[0,1,1]
    v_pk_fma_f32 v[94:95], v[116:117], v[70:71], v[50:51] op_sel_hi:[0,1,1]
    v_pk_fma_f32 v[96:97], v[116:117], v[72:73], v[52:53] op_sel_hi:[0,1,1]
    v_pk_fma_f32 v[98:99], v[116:117], v[74:75], v[54:55] op_sel_hi:[0,1,1]
    v_pk_fma_f32 v[100:101], v[118:119], v[68:69], v[48:49] op_sel_hi:[0,1,1]
    v_pk_fma_f32 v[102:103], v[118:119], v[70:71], v[50:51] op_sel_hi:[0,1,1]
    v_pk_fma_f32 v[104:105], v[118:119], v[72:73], v[52:53] op_sel_hi:[0,1,1]
    v_pk_fma_f32 v[106:107], v[118:119], v[74:75], v[54:55] op_sel_hi:[0,1,1]
    s_waitcnt lgkmcnt(0)
    v_mad_u32_u16 v110, v57, 36, v2 op_sel:[1,0,0,0]
    ds_read_b128 v[48:51], v110 offset:55296
    ds_read_b128 v[52:55], v110 offset:55424
    v_mad_u32_u16 v67, v57, s84, v3 op_sel:[1,0,0,0]
    s_cmp_ge_u32 s77, s74
    s_cbranch_scc1 B_tr8p
    ds_read_b128 v[112:115], v111 offset:3520
    ds_read_b128 v[116:119], v111 offset:3536
    s_cmp_ge_u32 s78, s74
    s_cbranch_scc1 B_rrP2
    s_lshl_b32 s51, s78, 4
    v_add_u32 v108, s51, v13
    ds_read_u16 v111, v108 offset:1056
    s_branch B_rrX2
B_rrP2:
    s_sub_u32 s79, s78, s74
    s_min_u32 s79, s79, 51
    s_lshl_b32 s51, s79, 4
    v_add_u32 v108, s51, v13
    ds_read_u16 v111, v108 offset:2656
B_rrX2:
    s_branch B_tr8xp
B_tr8p:
    s_sub_u32 s79, s78, s74
    s_min_u32 s79, s79, 51
    s_lshl_b32 s51, s79, 4
    v_add_u32 v108, s51, v13
    ds_read_u16 v111, v108 offset:2656
    s_waitcnt lgkmcnt(0)
    ds_read_b128 v[112:115], v111 offset:3488
    ds_read_b128 v[116:119], v111 offset:3504
B_tr8xp:
    s_mov_b64 exec, 1
    ds_add_rtn_u32 v64, v14, v15
    s_mov_b64 exec, -1
    s_waitcnt vmcnt(3)
    v_dot2_f32_bf16 v80, v32, s46, v80
    v_dot2_f32_bf16 v81, v33, s46, v81
    v_dot2_f32_bf16 v82, v34, s46, v82
    v_dot2_f32_bf16 v83, v35, s46, v83
    v_pk_add_f32 v[76:77], v[32:33], v[76:77]
    v_pk_add_f32 v[78:79], v[34:35], v[78:79]
    v_mad_u32_u16 v108, v57, s42, v2
    buffer_load_dwordx4 v[32:35], v108, s[12:15], 0 offen
    v_exp_f32 v16, v76
    v_exp_f32 v17, v77
    v_exp_f32 v18, v78
    v_exp_f32 v19, v79
    v_exp_f32 v20, v80
    v_exp_f32 v21, v81
    v_exp_f32 v22, v82
    v_exp_f32 v23, v83
    v_pk_add_f32 v[16:17], v[16:17], s[44:45]
    v_pk_add_f32 v[18:19], v[18:19], s[44:45]
    v_pk_add_f32 v[20:21], v[20:21], s[44:45]
    v_pk_add_f32 v[22:23], v[22:23], s[44:45]
    v_rcp_f32 v16, v16
    v_rcp_f32 v17, v17
    v_rcp_f32 v18, v18
    v_rcp_f32 v19, v19
    v_rcp_f32 v20, v20
    v_rcp_f32 v21, v21
    v_rcp_f32 v22, v22
    v_rcp_f32 v23, v23
    v_pk_fma_f32 v[120:121], v[76:77], v[16:17], v[120:121]
    v_pk_fma_f32 v[122:123], v[78:79], v[18:19], v[122:123]
    v_pk_fma_f32 v[124:125], v[80:81], v[20:21], v[124:125]
    v_pk_fma_f32 v[126:127], v[82:83], v[22:23], v[126:127]
    s_waitcnt vmcnt(3)
    v_dot2_f32_bf16 v88, v36, s46, v88
    v_dot2_f32_bf16 v89, v37, s46, v89
    v_dot2_f32_bf16 v90, v38, s46, v90
    v_dot2_f32_bf16 v91, v39, s46, v91
    v_pk_add_f32 v[84:85], v[36:37], v[84:85]
    v_pk_add_f32 v[86:87], v[38:39], v[86:87]
    v_mad_u32_u16 v109, v59, s42, v2
    buffer_load_dwordx4 v[36:39], v109, s[12:15], 0 offen
    v_exp_f32 v16, v84
    v_exp_f32 v17, v85
    v_exp_f32 v18, v86
    v_exp_f32 v19, v87
    v_exp_f32 v20, v88
    v_exp_f32 v21, v89
    v_exp_f32 v22, v90
    v_exp_f32 v23, v91
    v_pk_add_f32 v[16:17], v[16:17], s[44:45]
    v_pk_add_f32 v[18:19], v[18:19], s[44:45]
    v_pk_add_f32 v[20:21], v[20:21], s[44:45]
    v_pk_add_f32 v[22:23], v[22:23], s[44:45]
    v_rcp_f32 v16, v16
    v_rcp_f32 v17, v17
    v_rcp_f32 v18, v18
    v_rcp_f32 v19, v19
    v_rcp_f32 v20, v20
    v_rcp_f32 v21, v21
    v_rcp_f32 v22, v22
    v_rcp_f32 v23, v23
    v_pk_fma_f32 v[120:121], v[84:85], v[16:17], v[120:121]
    v_pk_fma_f32 v[122:123], v[86:87], v[18:19], v[122:123]
    v_pk_fma_f32 v[124:125], v[88:89], v[20:21], v[124:125]
    v_pk_fma_f32 v[126:127], v[90:91], v[22:23], v[126:127]
    s_waitcnt vmcnt(3)
    v_dot2_f32_bf16 v96, v40, s46, v96
    v_dot2_f32_bf16 v97, v41, s46, v97
    v_dot2_f32_bf16 v98, v42, s46, v98
    v_dot2_f32_bf16 v99, v43, s46, v99
    v_pk_add_f32 v[92:93], v[40:41], v[92:93]
    v_pk_add_f32 v[94:95], v[42:43], v[94:95]
    v_mad_u32_u16 v108, v61, s42, v2
    buffer_load_dwordx4 v[40:43], v108, s[12:15], 0 offen
    v_exp_f32 v16, v92
    v_exp_f32 v17, v93
    v_exp_f32 v18, v94
    v_exp_f32 v19, v95
    v_exp_f32 v20, v96
    v_exp_f32 v21, v97
    v_exp_f32 v22, v98
    v_exp_f32 v23, v99
    v_pk_add_f32 v[16:17], v[16:17], s[44:45]
    v_pk_add_f32 v[18:19], v[18:19], s[44:45]
    v_pk_add_f32 v[20:21], v[20:21], s[44:45]
    v_pk_add_f32 v[22:23], v[22:23], s[44:45]
    v_rcp_f32 v16, v16
    v_rcp_f32 v17, v17
    v_rcp_f32 v18, v18
    v_rcp_f32 v19, v19
    v_rcp_f32 v20, v20
    v_rcp_f32 v21, v21
    v_rcp_f32 v22, v22
    v_rcp_f32 v23, v23
    v_pk_fma_f32 v[120:121], v[92:93], v[16:17], v[120:121]
    v_pk_fma_f32 v[122:123], v[94:95], v[18:19], v[122:123]
    v_pk_fma_f32 v[124:125], v[96:97], v[20:21], v[124:125]
    v_pk_fma_f32 v[126:127], v[98:99], v[22:23], v[126:127]
    s_waitcnt vmcnt(3)
    v_dot2_f32_bf16 v104, v44, s46, v104
    v_dot2_f32_bf16 v105, v45, s46, v105
    v_dot2_f32_bf16 v106, v46, s46, v106
    v_dot2_f32_bf16 v107, v47, s46, v107
    v_pk_add_f32 v[100:101], v[44:45], v[100:101]
    v_pk_add_f32 v[102:103], v[46:47], v[102:103]
    v_mad_u32_u16 v109, v63, s42, v2
    buffer_load_dwordx4 v[44:47], v109, s[12:15], 0 offen
    v_exp_f32 v16, v100
    v_exp_f32 v17, v101
    v_exp_f32 v18, v102
    v_exp_f32 v19, v103
    v_exp_f32 v20, v104
    v_exp_f32 v21, v105
    v_exp_f32 v22, v106
    v_exp_f32 v23, v107
    v_pk_add_f32 v[16:17], v[16:17], s[44:45]
    v_pk_add_f32 v[18:19], v[18:19], s[44:45]
    v_pk_add_f32 v[20:21], v[20:21], s[44:45]
    v_pk_add_f32 v[22:23], v[22:23], s[44:45]
    v_rcp_f32 v16, v16
    v_rcp_f32 v17, v17
    v_rcp_f32 v18, v18
    v_rcp_f32 v19, v19
    v_rcp_f32 v20, v20
    v_rcp_f32 v21, v21
    v_rcp_f32 v22, v22
    v_rcp_f32 v23, v23
    v_pk_fma_f32 v[120:121], v[100:101], v[16:17], v[120:121]
    v_pk_fma_f32 v[122:123], v[102:103], v[18:19], v[122:123]
    v_pk_fma_f32 v[124:125], v[104:105], v[20:21], v[124:125]
    v_pk_fma_f32 v[126:127], v[106:107], v[22:23], v[126:127]
    v_cvt_f64_f32 v[16:17], v120
    v_cvt_f64_f32 v[18:19], v121
    v_cvt_f64_f32 v[20:21], v122
    v_cvt_f64_f32 v[22:23], v123
    v_cvt_f64_f32 v[24:25], v124
    v_cvt_f64_f32 v[26:27], v125
    v_cvt_f64_f32 v[28:29], v126
    v_cvt_f64_f32 v[30:31], v127
    ds_add_f64 v66, v[16:17] offset:0
    ds_add_f64 v66, v[18:19] offset:64
    ds_add_f64 v66, v[20:21] offset:128
    ds_add_f64 v66, v[22:23] offset:192
    ds_add_f64 v66, v[24:25] offset:256
    ds_add_f64 v66, v[26:27] offset:320
    ds_add_f64 v66, v[28:29] offset:384
    ds_add_f64 v66, v[30:31] offset:448
    s_add_u32 s83, s83, 2
    s_cmp_lt_u32 s83, 2
    s_cbranch_scc1 B_pr1
    s_setprio 2
    s_cmp_lt_u32 s83, 6
    s_cbranch_scc1 B_pr1
    s_setprio 1
    s_cmp_lt_u32 s83, 7
    s_cbranch_scc1 B_pr1
    s_setprio 0
B_pr1:
    s_mov_b32 s76, s77
    s_mov_b32 s77, s78
    s_cmp_lt_u32 s76, s74
    s_cbranch_scc1 B_loop8p
    s_cmp_lt_u32 s76, s75
    s_cbranch_scc1 B_loop0p
    s_branch B_loop_end
B_pre4:
    s_waitcnt lgkmcnt(0)
    s_sub_u32 s79, s76, s74
    s_min_u32 s79, s79, 51
    s_lshl_b32 s51, s79, 4
    v_add_u32 v108, s51, v13
    ds_read_u16 v111, v108 offset:2656
    s_waitcnt lgkmcnt(0)
    ds_read_b128 v[56:59], v111 offset:3488
    ds_read_b128 v[60:63], v111 offset:3504
    s_sub_u32 s79, s77, s74
    s_min_u32 s79, s79, 51
    s_lshl_b32 s51, s79, 4
    v_add_u32 v108, s51, v13
    ds_read_u16 v111, v108 offset:2656
    s_waitcnt lgkmcnt(0)
    v_mad_u32_u16 v108, v57, s42, v2
    buffer_load_dwordx4 v[32:35], v108, s[12:15], 0 offen
    v_mad_u32_u16 v109, v59, s42, v2
    buffer_load_dwordx4 v[36:39], v109, s[12:15], 0 offen
    v_mad_u32_u16 v108, v61, s42, v2
    buffer_load_dwordx4 v[40:43], v108, s[12:15], 0 offen
    v_mad_u32_u16 v109, v63, s42, v2
    buffer_load_dwordx4 v[44:47], v109, s[12:15], 0 offen
    v_mad_u32_u16 v110, v57, 36, v2 op_sel:[1,0,0,0]
    ds_read_b128 v[48:51], v110 offset:55296
    ds_read_b128 v[52:55], v110 offset:55424
    v_mad_u32_u16 v67, v57, s84, v3 op_sel:[1,0,0,0]
    ds_read_b128 v[112:115], v111 offset:3488
    ds_read_b128 v[116:119], v111 offset:3504
    s_waitcnt lgkmcnt(0)
    s_cmp_lg_u32 s90, 0
    s_cbranch_scc1 B_loop0p
B_loop0:
    s_waitcnt lgkmcnt(8)
    v_mov_b32 v66, v67
    v_readfirstlane_b32 s78, v64
    s_nop 0
    s_add_u32 s78, s78, 20
    s_sub_u32 s79, s78, s74
    s_min_u32 s79, s79, 51
    s_lshl_b32 s51, s79, 4
    v_add_u32 v108, s51, v13
    ds_read_u16 v111, v108 offset:2656
    v_pk_fma_f32 v[76:77], v[56:57], v[68:69], v[48:49] op_sel_hi:[0,1,1]
    v_pk_fma_f32 v[78:79], v[56:57], v[70:71], v[50:51] op_sel_hi:[0,1,1]
    v_pk_fma_f32 v[80:81], v[56:57], v[72:73], v[52:53] op_sel_hi:[0,1,1]
    v_pk_fma_f32 v[82:83], v[56:57], v[74:75], v[54:55] op_sel_hi:[0,1,1]
    v_pk_fma_f32 v[84:85], v[58:59], v[68:69], v[48:49] op_sel_hi:[0,1,1]
    v_pk_fma_f32 v[86:87], v[58:59], v[70:71], v[50:51] op_sel_hi:[0,1,1]
    v_pk_fma_f32 v[88:89], v[58:59], v[72:73], v[52:53] op_sel_hi:[0,1,1]
    v_pk_fma_f32 v[90:91], v[58:59], v[74:75], v[54:55] op_sel_hi:[0,1,1]
    v_pk_fma_f32 v[92:93], v[60:61], v[68:69], v[48:49] op_sel_hi:[0,1,1]
    v_pk_fma_f32 v[94:95], v[60:61], v[70:71], v[50:51] op_sel_hi:[0,1,1]
    v_pk_fma_f32 v[96:97], v[60:61], v[72:73], v[52:53] op_sel_hi:[0,1,1]
    v_pk_fma_f32 v[98:99], v[60:61], v[74:75], v[54:55] op_sel_hi:[0,1,1]
    v_pk_fma_f32 v[100:101], v[62:63], v[68:69], v[48:49] op_sel_hi:[0,1,1]
    v_pk_fma_f32 v[102:103], v[62:63], v[70:71], v[50:51] op_sel_hi:[0,1,1]
    v_pk_fma_f32 v[104:105], v[62:63], v[72:73], v[52:53] op_sel_hi:[0,1,1]
    v_pk_fma_f32 v[106:107], v[62:63], v[74:75], v[54:55] op_sel_hi:[0,1,1]
    v_mad_u32_u16 v110, v113, 36, v2 op_sel:[1,0,0,0]
    ds_read_b128 v[48:51], v110 offset:55296
    ds_read_b128 v[52:55], v110 offset:55424
    v_mad_u32_u16 v67, v113, s84, v3 op_sel:[1,0,0,0]
    s_waitcnt lgkmcnt(2)
    ds_read_b128 v[56:59], v111 offset:3488
    ds_read_b128 v[60:63], v111 offset:3504
    s_mov_b64 exec, 1
    ds_add_rtn_u32 v64, v14, v15
    s_mov_b64 exec, -1
    s_waitcnt vmcnt(3)
    v_dot2_f32_bf16 v80, v32, s46, v80
    v_dot2_f32_bf16 v81, v33, s46, v81
    v_dot2_f32_bf16 v82, v34, s46, v82
    v_dot2_f32_bf16 v83, v35, s46, v83
    v_pk_add_f32 v[76:77], v[32:33], v[76:77]
    v_pk_add_f32 v[78:79], v[34:35], v[78:79]
    v_mad_u32_u16 v108, v113, s42, v2
    buffer_load_dwordx4 v[32:35], v108, s[12:15], 0 offen
    v_exp_f32 v4, v76
    v_exp_f32 v5, v77
    v_exp_f32 v6, v78
    v_exp_f32 v7, v79
    v_exp_f32 v8, v80
    v_exp_f32 v9, v81
    v_exp_f32 v10, v82
    v_exp_f32 v11, v83
    v_pk_add_f32 v[4:5], v[4:5], s[44:45]
    v_pk_add_f32 v[6:7], v[6:7], s[44:45]
    v_pk_add_f32 v[8:9], v[8:9], s[44:45]
    v_pk_add_f32 v[10:11], v[10:11], s[44:45]
    s_cmp_ge_u32 s76, s82
    s_cbranch_scc1 B_ex0_0
    s_waitcnt vmcnt(3)
    v_dot2_f32_bf16 v88, v36, s46, v88
    v_dot2_f32_bf16 v89, v37, s46, v89
    v_dot2_f32_bf16 v90, v38, s46, v90
    v_dot2_f32_bf16 v91, v39, s46, v91
    v_pk_add_f32 v[84:85], v[36:37], v[84:85]
    v_pk_add_f32 v[86:87], v[38:39], v[86:87]
    v_mad_u32_u16 v109, v115, s42, v2
    buffer_load_dwordx4 v[36:39], v109, s[12:15], 0 offen
    v_exp_f32 v16, v84
    v_exp_f32 v17, v85
    v_exp_f32 v18, v86
    v_exp_f32 v19, v87
    v_exp_f32 v20, v88
    v_exp_f32 v21, v89
    v_exp_f32 v22, v90
    v_exp_f32 v23, v91
    v_pk_fma_f32 v[84:85], v[84:85], v[4:5], v[76:77]
    v_pk_fma_f32 v[86:87], v[86:87], v[6:7], v[78:79]
    v_pk_fma_f32 v[88:89], v[88:89], v[8:9], v[80:81]
    v_pk_fma_f32 v[90:91], v[90:91], v[10:11], v[82:83]
    v_pk_fma_f32 v[120:121], v[76:77], v[16:17], v[84:85]
    v_pk_fma_f32 v[122:123], v[78:79], v[18:19], v[86:87]
    v_pk_fma_f32 v[124:125], v[80:81], v[20:21], v[88:89]
    v_pk_fma_f32 v[126:127], v[82:83], v[22:23], v[90:91]
    v_pk_fma_f32 v[4:5], v[4:5], v[16:17], v[4:5]
    v_pk_fma_f32 v[6:7], v[6:7], v[18:19], v[6:7]
    v_pk_fma_f32 v[8:9], v[8:9], v[20:21], v[8:9]
    v_pk_fma_f32 v[10:11], v[10:11], v[22:23], v[10:11]
    s_cmp_ge_u32 s76, s73
    s_cbranch_scc1 B_ex1_0
    s_waitcnt vmcnt(3)
    v_dot2_f32_bf16 v96, v40, s46, v96
    v_dot2_f32_bf16 v97, v41, s46, v97
    v_dot2_f32_bf16 v98, v42, s46, v98
    v_dot2_f32_bf16 v99, v43, s46, v99
    v_pk_add_f32 v[92:93], v[40:41], v[92:93]
    v_pk_add_f32 v[94:95], v[42:43], v[94:95]
    v_mad_u32_u16 v108, v117, s42, v2
    buffer_load_dwordx4 v[40:43], v108, s[12:15], 0 offen
    v_exp_f32 v16, v92
    v_exp_f32 v17, v93
    v_exp_f32 v18, v94
    v_exp_f32 v19, v95
    v_exp_f32 v20, v96
    v_exp_f32 v21, v97
    v_exp_f32 v22, v98
    v_exp_f32 v23, v99
    v_pk_fma_f32 v[92:93], v[92:93], v[4:5], v[120:121]
    v_pk_fma_f32 v[94:95], v[94:95], v[6:7], v[122:123]
    v_pk_fma_f32 v[96:97], v[96:97], v[8:9], v[124:125]
    v_pk_fma_f32 v[98:99], v[98:99], v[10:11], v[126:127]
    v_pk_fma_f32 v[120:121], v[120:121], v[16:17], v[92:93]
    v_pk_fma_f32 v[122:123], v[122:123], v[18:19], v[94:95]
    v_pk_fma_f32 v[124:125], v[124:125], v[20:21], v[96:97]
    v_pk_fma_f32 v[126:127], v[126:127], v[22:23], v[98:99]
    v_pk_fma_f32 v[4:5], v[4:5], v[16:17], v[4:5]
    v_pk_fma_f32 v[6:7], v[6:7], v[18:19], v[6:7]
    v_pk_fma_f32 v[8:9], v[8:9], v[20:21], v[8:9]
    v_pk_fma_f32 v[10:11], v[10:11], v[22:23], v[10:11]
    s_cmp_ge_u32 s76, s72
    s_cbranch_scc1 B_ex2_0
    s_waitcnt vmcnt(3)
    v_dot2_f32_bf16 v104, v44, s46, v104
    v_dot2_f32_bf16 v105, v45, s46, v105
    v_dot2_f32_bf16 v106, v46, s46, v106
    v_dot2_f32_bf16 v107, v47, s46, v107
    v_pk_add_f32 v[100:101], v[44:45], v[100:101]
    v_pk_add_f32 v[102:103], v[46:47], v[102:103]
    v_mad_u32_u16 v109, v119, s42, v2
    buffer_load_dwordx4 v[44:47], v109, s[12:15], 0 offen
    v_exp_f32 v16, v100
    v_exp_f32 v17, v101
    v_exp_f32 v18, v102
    v_exp_f32 v19, v103
    v_exp_f32 v20, v104
    v_exp_f32 v21, v105
    v_exp_f32 v22, v106
    v_exp_f32 v23, v107
    v_pk_fma_f32 v[100:101], v[100:101], v[4:5], v[120:121]
    v_pk_fma_f32 v[102:103], v[102:103], v[6:7], v[122:123]
    v_pk_fma_f32 v[104:105], v[104:105], v[8:9], v[124:125]
    v_pk_fma_f32 v[106:107], v[106:107], v[10:11], v[126:127]
    v_pk_fma_f32 v[120:121], v[120:121], v[16:17], v[100:101]
    v_pk_fma_f32 v[122:123], v[122:123], v[18:19], v[102:103]
    v_pk_fma_f32 v[124:125], v[124:125], v[20:21], v[104:105]
    v_pk_fma_f32 v[126:127], v[126:127], v[22:23], v[106:107]
    v_pk_fma_f32 v[4:5], v[4:5], v[16:17], v[4:5]
    v_pk_fma_f32 v[6:7], v[6:7], v[18:19], v[6:7]
    v_pk_fma_f32 v[8:9], v[8:9], v[20:21], v[8:9]
    v_pk_fma_f32 v[10:11], v[10:11], v[22:23], v[10:11]
B_fin_0:
    v_rcp_f32 v4, v4
    v_rcp_f32 v5, v5
    v_rcp_f32 v6, v6
    v_rcp_f32 v7, v7
    v_rcp_f32 v8, v8
    v_rcp_f32 v9, v9
    v_rcp_f32 v10, v10
    v_rcp_f32 v11, v11
    v_pk_mul_f32 v[4:5], v[120:121], v[4:5]
    v_pk_mul_f32 v[6:7], v[122:123], v[6:7]
    v_pk_mul_f32 v[8:9], v[124:125], v[8:9]
    v_pk_mul_f32 v[10:11], v[126:127], v[10:11]
    v_cvt_f64_f32 v[16:17], v4
    v_cvt_f64_f32 v[18:19], v5
    v_cvt_f64_f32 v[20:21], v6
    v_cvt_f64_f32 v[22:23], v7
    v_cvt_f64_f32 v[24:25], v8
    v_cvt_f64_f32 v[26:27], v9
    v_cvt_f64_f32 v[28:29], v10
    v_cvt_f64_f32 v[30:31], v11
    ds_add_f64 v66, v[16:17] offset:0
    ds_add_f64 v66, v[18:19] offset:64
    ds_add_f64 v66, v[20:21] offset:128
    ds_add_f64 v66, v[22:23] offset:192
    ds_add_f64 v66, v[24:25] offset:256
    ds_add_f64 v66, v[26:27] offset:320
    ds_add_f64 v66, v[28:29] offset:384
    ds_add_f64 v66, v[30:31] offset:448
B_nx_0:
    s_add_u32 s83, s83, 1
    s_cmp_lt_u32 s83, 2
    s_cbranch_scc1 B_pr2
    s_setprio 2
    s_cmp_lt_u32 s83, 6
    s_cbranch_scc1 B_pr2
    s_setprio 1
    s_cmp_lt_u32 s83, 7
    s_cbranch_scc1 B_pr2
    s_setprio 0
B_pr2:
    s_mov_b32 s76, s77
    s_mov_b32 s77, s78
    s_cmp_ge_u32 s76, s75
    s_cbranch_scc1 B_loop_end
B_loop1:
    s_waitcnt lgkmcnt(8)
    v_mov_b32 v66, v67
    v_readfirstlane_b32 s78, v64
    s_nop 0
    s_add_u32 s78, s78, 20
    s_sub_u32 s79, s78, s74
    s_min_u32 s79, s79, 51
    s_lshl_b32 s51, s79, 4
    v_add_u32 v108, s51, v13
    ds_read_u16 v111, v108 offset:2656
    v_pk_fma_f32 v[76:77], v[112:113], v[68:69], v[48:49] op_sel_hi:[0,1,1]
    v_pk_fma_f32 v[78:79], v[112:113], v[70:71], v[50:51] op_sel_hi:[0,1,1]
    v_pk_fma_f32 v[80:81], v[112:113], v[72:73], v[52:53] op_sel_hi:[0,1,1]
    v_pk_fma_f32 v[82:83], v[112:113], v[74:75], v[54:55] op_sel_hi:[0,1,1]
    v_pk_fma_f32 v[84:85], v[114:115], v[68:69], v[48:49] op_sel_hi:[0,1,1]
    v_pk_fma_f32 v[86:87], v[114:115], v[70:71], v[50:51] op_sel_hi:[0,1,1]
    v_pk_fma_f32 v[88:89], v[114:115], v[72:73], v[52:53] op_sel_hi:[0,1,1]
    v_pk_fma_f32 v[90:91], v[114:115], v[74:75], v[54:55] op_sel_hi:[0,1,1]
    v_pk_fma_f32 v[92:93], v[116:117], v[68:69], v[48:49] op_sel_hi:[0,1,1]
    v_pk_fma_f32 v[94:95], v[116:117], v[70:71], v[50:51] op_sel_hi:[0,1,1]
    v_pk_fma_f32 v[96:97], v[116:117], v[72:73], v[52:53] op_sel_hi:[0,1,1]
    v_pk_fma_f32 v[98:99], v[116:117], v[74:75], v[54:55] op_sel_hi:[0,1,1]
    v_pk_fma_f32 v[100:101], v[118:119], v[68:69], v[48:49] op_sel_hi:[0,1,1]
    v_pk_fma_f32 v[102:103], v[118:119], v[70:71], v[50:51] op_sel_hi:[0,1,1]
    v_pk_fma_f32 v[104:105], v[118:119], v[72:73], v[52:53] op_sel_hi:[0,1,1]
    v_pk_fma_f32 v[106:107], v[118:119], v[74:75], v[54:55] op_sel_hi:[0,1,1]
    v_mad_u32_u16 v110, v57, 36, v2 op_sel:[1,0,0,0]
    ds_read_b128 v[48:51], v110 offset:55296
    ds_read_b128 v[52:55], v110 offset:55424
    v_mad_u32_u16 v67, v57, s84, v3 op_sel:[1,0,0,0]
    s_waitcnt lgkmcnt(2)
    ds_read_b128 v[112:115], v111 offset:3488
    ds_read_b128 v[116:119], v111 offset:3504
    s_mov_b64 exec, 1
    ds_add_rtn_u32 v64, v14, v15
    s_mov_b64 exec, -1
    s_waitcnt vmcnt(3)
    v_dot2_f32_bf16 v80, v32, s46, v80
    v_dot2_f32_bf16 v81, v33, s46, v81
    v_dot2_f32_bf16 v82, v34, s46, v82
    v_dot2_f32_bf16 v83, v35, s46, v83
    v_pk_add_f32 v[76:77], v[32:33], v[76:77]
    v_pk_add_f32 v[78:79], v[34:35], v[78:79]
    v_mad_u32_u16 v108, v57, s42, v2
    buffer_load_dwordx4 v[32:35], v108, s[12:15], 0 offen
    v_exp_f32 v4, v76
    v_exp_f32 v5, v77
    v_exp_f32 v6, v78
    v_exp_f32 v7, v79
    v_exp_f32 v8, v80
    v_exp_f32 v9, v81
    v_exp_f32 v10, v82
    v_exp_f32 v11, v83
    v_pk_add_f32 v[4:5], v[4:5], s[44:45]
    v_pk_add_f32 v[6:7], v[6:7], s[44:45]
    v_pk_add_f32 v[8:9], v[8:9], s[44:45]
    v_pk_add_f32 v[10:11], v[10:11], s[44:45]
    s_cmp_ge_u32 s76, s82
    s_cbranch_scc1 B_ex0_1
    s_waitcnt vmcnt(3)
    v_dot2_f32_bf16 v88, v36, s46, v88
    v_dot2_f32_bf16 v89, v37, s46, v89
    v_dot2_f32_bf16 v90, v38, s46, v90
    v_dot2_f32_bf16 v91, v39, s46, v91
    v_pk_add_f32 v[84:85], v[36:37], v[84:85]
    v_pk_add_f32 v[86:87], v[38:39], v[86:87]
    v_mad_u32_u16 v109, v59, s42, v2
    buffer_load_dwordx4 v[36:39], v109, s[12:15], 0 offen
    v_exp_f32 v16, v84
    v_exp_f32 v17, v85
    v_exp_f32 v18, v86
    v_exp_f32 v19, v87
    v_exp_f32 v20, v88
    v_exp_f32 v21, v89
    v_exp_f32 v22, v90
    v_exp_f32 v23, v91
    v_pk_fma_f32 v[84:85], v[84:85], v[4:5], v[76:77]
    v_pk_fma_f32 v[86:87], v[86:87], v[6:7], v[78:79]
    v_pk_fma_f32 v[88:89], v[88:89], v[8:9], v[80:81]
    v_pk_fma_f32 v[90:91], v[90:91], v[10:11], v[82:83]
    v_pk_fma_f32 v[120:121], v[76:77], v[16:17], v[84:85]
    v_pk_fma_f32 v[122:123], v[78:79], v[18:19], v[86:87]
    v_pk_fma_f32 v[124:125], v[80:81], v[20:21], v[88:89]
    v_pk_fma_f32 v[126:127], v[82:83], v[22:23], v[90:91]
    v_pk_fma_f32 v[4:5], v[4:5], v[16:17], v[4:5]
    v_pk_fma_f32 v[6:7], v[6:7], v[18:19], v[6:7]
    v_pk_fma_f32 v[8:9], v[8:9], v[20:21], v[8:9]
    v_pk_fma_f32 v[10:11], v[10:11], v[22:23], v[10:11]
    s_cmp_ge_u32 s76, s73
    s_cbranch_scc1 B_ex1_1
    s_waitcnt vmcnt(3)
    v_dot2_f32_bf16 v96, v40, s46, v96
    v_dot2_f32_bf16 v97, v41, s46, v97
    v_dot2_f32_bf16 v98, v42, s46, v98
    v_dot2_f32_bf16 v99, v43, s46, v99
    v_pk_add_f32 v[92:93], v[40:41], v[92:93]
    v_pk_add_f32 v[94:95], v[42:43], v[94:95]
    v_mad_u32_u16 v108, v61, s42, v2
    buffer_load_dwordx4 v[40:43], v108, s[12:15], 0 offen
    v_exp_f32 v16, v92
    v_exp_f32 v17, v93
    v_exp_f32 v18, v94
    v_exp_f32 v19, v95
    v_exp_f32 v20, v96
    v_exp_f32 v21, v97
    v_exp_f32 v22, v98
    v_exp_f32 v23, v99
    v_pk_fma_f32 v[92:93], v[92:93], v[4:5], v[120:121]
    v_pk_fma_f32 v[94:95], v[94:95], v[6:7], v[122:123]
    v_pk_fma_f32 v[96:97], v[96:97], v[8:9], v[124:125]
    v_pk_fma_f32 v[98:99], v[98:99], v[10:11], v[126:127]
    v_pk_fma_f32 v[120:121], v[120:121], v[16:17], v[92:93]
    v_pk_fma_f32 v[122:123], v[122:123], v[18:19], v[94:95]
    v_pk_fma_f32 v[124:125], v[124:125], v[20:21], v[96:97]
    v_pk_fma_f32 v[126:127], v[126:127], v[22:23], v[98:99]
    v_pk_fma_f32 v[4:5], v[4:5], v[16:17], v[4:5]
    v_pk_fma_f32 v[6:7], v[6:7], v[18:19], v[6:7]
    v_pk_fma_f32 v[8:9], v[8:9], v[20:21], v[8:9]
    v_pk_fma_f32 v[10:11], v[10:11], v[22:23], v[10:11]
    s_cmp_ge_u32 s76, s72
    s_cbranch_scc1 B_ex2_1
    s_waitcnt vmcnt(3)
    v_dot2_f32_bf16 v104, v44, s46, v104
    v_dot2_f32_bf16 v105, v45, s46, v105
    v_dot2_f32_bf16 v106, v46, s46, v106
    v_dot2_f32_bf16 v107, v47, s46, v107
    v_pk_add_f32 v[100:101], v[44:45], v[100:101]
    v_pk_add_f32 v[102:103], v[46:47], v[102:103]
    v_mad_u32_u16 v109, v63, s42, v2
    buffer_load_dwordx4 v[44:47], v109, s[12:15], 0 offen
    v_exp_f32 v16, v100
    v_exp_f32 v17, v101
    v_exp_f32 v18, v102
    v_exp_f32 v19, v103
    v_exp_f32 v20, v104
    v_exp_f32 v21, v105
    v_exp_f32 v22, v106
    v_exp_f32 v23, v107
    v_pk_fma_f32 v[100:101], v[100:101], v[4:5], v[120:121]
    v_pk_fma_f32 v[102:103], v[102:103], v[6:7], v[122:123]
    v_pk_fma_f32 v[104:105], v[104:105], v[8:9], v[124:125]
    v_pk_fma_f32 v[106:107], v[106:107], v[10:11], v[126:127]
    v_pk_fma_f32 v[120:121], v[120:121], v[16:17], v[100:101]
    v_pk_fma_f32 v[122:123], v[122:123], v[18:19], v[102:103]
    v_pk_fma_f32 v[124:125], v[124:125], v[20:21], v[104:105]
    v_pk_fma_f32 v[126:127], v[126:127], v[22:23], v[106:107]
    v_pk_fma_f32 v[4:5], v[4:5], v[16:17], v[4:5]
    v_pk_fma_f32 v[6:7], v[6:7], v[18:19], v[6:7]
    v_pk_fma_f32 v[8:9], v[8:9], v[20:21], v[8:9]
    v_pk_fma_f32 v[10:11], v[10:11], v[22:23], v[10:11]
B_fin_1:
    v_rcp_f32 v4, v4
    v_rcp_f32 v5, v5
    v_rcp_f32 v6, v6
    v_rcp_f32 v7, v7
    v_rcp_f32 v8, v8
    v_rcp_f32 v9, v9
    v_rcp_f32 v10, v10
    v_rcp_f32 v11, v11
    v_pk_mul_f32 v[4:5], v[120:121], v[4:5]
    v_pk_mul_f32 v[6:7], v[122:123], v[6:7]
    v_pk_mul_f32 v[8:9], v[124:125], v[8:9]
    v_pk_mul_f32 v[10:11], v[126:127], v[10:11]
    v_cvt_f64_f32 v[16:17], v4
    v_cvt_f64_f32 v[18:19], v5
    v_cvt_f64_f32 v[20:21], v6
    v_cvt_f64_f32 v[22:23], v7
    v_cvt_f64_f32 v[24:25], v8
    v_cvt_f64_f32 v[26:27], v9
    v_cvt_f64_f32 v[28:29], v10
    v_cvt_f64_f32 v[30:31], v11
    ds_add_f64 v66, v[16:17] offset:0
    ds_add_f64 v66, v[18:19] offset:64
    ds_add_f64 v66, v[20:21] offset:128
    ds_add_f64 v66, v[22:23] offset:192
    ds_add_f64 v66, v[24:25] offset:256
    ds_add_f64 v66, v[26:27] offset:320
    ds_add_f64 v66, v[28:29] offset:384
    ds_add_f64 v66, v[30:31] offset:448
B_nx_1:
    s_add_u32 s83, s83, 1
    s_cmp_lt_u32 s83, 2
    s_cbranch_scc1 B_pr3
    s_setprio 2
    s_cmp_lt_u32 s83, 6
    s_cbranch_scc1 B_pr3
    s_setprio 1
    s_cmp_lt_u32 s83, 7
    s_cbranch_scc1 B_pr3
    s_setprio 0
B_pr3:
    s_mov_b32 s76, s77
    s_mov_b32 s77, s78
    s_cmp_ge_u32 s76, s75
    s_cbranch_scc1 B_loop_end
    s_branch B_loop0
B_ex0_0:
    v_mad_u32_u16 v109, v115, s42, v2
    buffer_load_dwordx4 v[36:39], v109, s[12:15], 0 offen
    v_mad_u32_u16 v108, v117, s42, v2
    buffer_load_dwordx4 v[40:43], v108, s[12:15], 0 offen
    v_mad_u32_u16 v109, v119, s42, v2
    buffer_load_dwordx4 v[44:47], v109, s[12:15], 0 offen
    v_rcp_f32 v4, v4
    v_rcp_f32 v5, v5
    v_rcp_f32 v6, v6
    v_rcp_f32 v7, v7
    v_rcp_f32 v8, v8
    v_rcp_f32 v9, v9
    v_rcp_f32 v10, v10
    v_rcp_f32 v11, v11
    v_pk_mul_f32 v[4:5], v[76:77], v[4:5]
    v_pk_mul_f32 v[6:7], v[78:79], v[6:7]
    v_pk_mul_f32 v[8:9], v[80:81], v[8:9]
    v_pk_mul_f32 v[10:11], v[82:83], v[10:11]
    v_cvt_f64_f32 v[16:17], v4
    v_cvt_f64_f32 v[18:19], v5
    v_cvt_f64_f32 v[20:21], v6
    v_cvt_f64_f32 v[22:23], v7
    v_cvt_f64_f32 v[24:25], v8
    v_cvt_f64_f32 v[26:27], v9
    v_cvt_f64_f32 v[28:29], v10
    v_cvt_f64_f32 v[30:31], v11
    ds_add_f64 v66, v[16:17] offset:0
    ds_add_f64 v66, v[18:19] offset:64
    ds_add_f64 v66, v[20:21] offset:128
    ds_add_f64 v66, v[22:23] offset:192
    ds_add_f64 v66, v[24:25] offset:256
    ds_add_f64 v66, v[26:27] offset:320
    ds_add_f64 v66, v[28:29] offset:384
    ds_add_f64 v66, v[30:31] offset:448
    s_branch B_nx_0
B_ex1_0:
    v_mad_u32_u16 v108, v117, s42, v2
    buffer_load_dwordx4 v[40:43], v108, s[12:15], 0 offen
    v_mad_u32_u16 v109, v119, s42, v2
    buffer_load_dwordx4 v[44:47], v109, s[12:15], 0 offen
    s_branch B_fin_0
B_ex2_0:
    v_mad_u32_u16 v109, v119, s42, v2
    buffer_load_dwordx4 v[44:47], v109, s[12:15], 0 offen
    s_branch B_fin_0
B_ex0_1:
    v_mad_u32_u16 v109, v59, s42, v2
    buffer_load_dwordx4 v[36:39], v109, s[12:15], 0 offen
    v_mad_u32_u16 v108, v61, s42, v2
    buffer_load_dwordx4 v[40:43], v108, s[12:15], 0 offen
    v_mad_u32_u16 v109, v63, s42, v2
    buffer_load_dwordx4 v[44:47], v109, s[12:15], 0 offen
    v_rcp_f32 v4, v4
    v_rcp_f32 v5, v5
    v_rcp_f32 v6, v6
    v_rcp_f32 v7, v7
    v_rcp_f32 v8, v8
    v_rcp_f32 v9, v9
    v_rcp_f32 v10, v10
    v_rcp_f32 v11, v11
    v_pk_mul_f32 v[4:5], v[76:77], v[4:5]
    v_pk_mul_f32 v[6:7], v[78:79], v[6:7]
    v_pk_mul_f32 v[8:9], v[80:81], v[8:9]
    v_pk_mul_f32 v[10:11], v[82:83], v[10:11]
    v_cvt_f64_f32 v[16:17], v4
    v_cvt_f64_f32 v[18:19], v5
    v_cvt_f64_f32 v[20:21], v6
    v_cvt_f64_f32 v[22:23], v7
    v_cvt_f64_f32 v[24:25], v8
    v_cvt_f64_f32 v[26:27], v9
    v_cvt_f64_f32 v[28:29], v10
    v_cvt_f64_f32 v[30:31], v11
    ds_add_f64 v66, v[16:17] offset:0
    ds_add_f64 v66, v[18:19] offset:64
    ds_add_f64 v66, v[20:21] offset:128
    ds_add_f64 v66, v[22:23] offset:192
    ds_add_f64 v66, v[24:25] offset:256
    ds_add_f64 v66, v[26:27] offset:320
    ds_add_f64 v66, v[28:29] offset:384
    ds_add_f64 v66, v[30:31] offset:448
    s_branch B_nx_1
B_ex1_1:
    v_mad_u32_u16 v108, v61, s42, v2
    buffer_load_dwordx4 v[40:43], v108, s[12:15], 0 offen
    v_mad_u32_u16 v109, v63, s42, v2
    buffer_load_dwordx4 v[44:47], v109, s[12:15], 0 offen
    s_branch B_fin_1
B_ex2_1:
    v_mad_u32_u16 v109, v63, s42, v2
    buffer_load_dwordx4 v[44:47], v109, s[12:15], 0 offen
    s_branch B_fin_1
B_loop0p:
    s_waitcnt lgkmcnt(8)
    v_mov_b32 v66, v67
    v_readfirstlane_b32 s78, v64
    s_nop 0
    s_add_u32 s78, s78, 20
    s_sub_u32 s79, s78, s74
    s_min_u32 s79, s79, 51
    s_lshl_b32 s51, s79, 4
    v_add_u32 v108, s51, v13
    ds_read_u16 v111, v108 offset:2656
    v_pk_fma_f32 v[76:77], v[56:57], v[68:69], v[48:49] op_sel_hi:[0,1,1]
    v_pk_fma_f32 v[78:79], v[56:57], v[70:71], v[50:51] op_sel_hi:[0,1,1]
    v_pk_fma_f32 v[80:81], v[56:57], v[72:73], v[52:53] op_sel_hi:[0,1,1]
    v_pk_fma_f32 v[82:83], v[56:57], v[74:75], v[54:55] op_sel_hi:[0,1,1]
    v_pk_fma_f32 v[84:85], v[58:59], v[68:69], v[48:49] op_sel_hi:[0,1,1]
    v_pk_fma_f32 v[86:87], v[58:59], v[70:71], v[50:51] op_sel_hi:[0,1,1]
    v_pk_fma_f32 v[88:89], v[58:59], v[72:73], v[52:53] op_sel_hi:[0,1,1]
    v_pk_fma_f32 v[90:91], v[58:59], v[74:75], v[54:55] op_sel_hi:[0,1,1]
    v_pk_fma_f32 v[92:93], v[60:61], v[68:69], v[48:49] op_sel_hi:[0,1,1]
    v_pk_fma_f32 v[94:95], v[60:61], v[70:71], v[50:51] op_sel_hi:[0,1,1]
    v_pk_fma_f32 v[96:97], v[60:61], v[72:73], v[52:53] op_sel_hi:[0,1,1]
    v_pk_fma_f32 v[98:99], v[60:61], v[74:75], v[54:55] op_sel_hi:[0,1,1]
    v_pk_fma_f32 v[100:101], v[62:63], v[68:69], v[48:49] op_sel_hi:[0,1,1]
    v_pk_fma_f32 v[102:103], v[62:63], v[70:71], v[50:51] op_sel_hi:[0,1,1]
    v_pk_fma_f32 v[104:105], v[62:63], v[72:73], v[52:53] op_sel_hi:[0,1,1]
    v_pk_fma_f32 v[106:107], v[62:63], v[74:75], v[54:55] op_sel_hi:[0,1,1]
    v_mad_u32_u16 v110, v113, 36, v2 op_sel:[1,0,0,0]
    ds_read_b128 v[48:51], v110 offset:55296
    ds_read_b128 v[52:55], v110 offset:55424
    v_mad_u32_u16 v67, v113, s84, v3 op_sel:[1,0,0,0]
    s_waitcnt lgkmcnt(2)
    ds_read_b128 v[56:59], v111 offset:3488
    ds_read_b128 v[60:63], v111 offset:3504
    s_mov_b64 exec, 1
    ds_add_rtn_u32 v64, v14, v15
    s_mov_b64 exec, -1
    s_waitcnt vmcnt(3)
    v_dot2_f32_bf16 v80, v32, s46, v80
    v_dot2_f32_bf16 v81, v33, s46, v81
    v_dot2_f32_bf16 v82, v34, s46, v82
    v_dot2_f32_bf16 v83, v35, s46, v83
    v_pk_add_f32 v[76:77], v[32:33], v[76:77]
    v_pk_add_f32 v[78:79], v[34:35], v[78:79]
    v_mad_u32_u16 v108, v113, s42, v2
    buffer_load_dwordx4 v[32:35], v108, s[12:15], 0 offen
    v_exp_f32 v16, v76
    v_exp_f32 v17, v77
    v_exp_f32 v18, v78
    v_exp_f32 v19, v79
    v_exp_f32 v20, v80
    v_exp_f32 v21, v81
    v_exp_f32 v22, v82
    v_exp_f32 v23, v83
    v_pk_add_f32 v[16:17], v[16:17], s[44:45]
    v_pk_add_f32 v[18:19], v[18:19], s[44:45]
    v_pk_add_f32 v[20:21], v[20:21], s[44:45]
    v_pk_add_f32 v[22:23], v[22:23], s[44:45]
    v_rcp_f32 v16, v16
    v_rcp_f32 v17, v17
    v_rcp_f32 v18, v18
    v_rcp_f32 v19, v19
    v_rcp_f32 v20, v20
    v_rcp_f32 v21, v21
    v_rcp_f32 v22, v22
    v_rcp_f32 v23, v23
    v_pk_mul_f32 v[120:121], v[76:77], v[16:17]
    v_pk_mul_f32 v[122:123], v[78:79], v[18:19]
    v_pk_mul_f32 v[124:125], v[80:81], v[20:21]
    v_pk_mul_f32 v[126:127], v[82:83], v[22:23]
    s_cmp_ge_u32 s76, s82
    s_cbranch_scc1 B_ex0_0p
    s_waitcnt vmcnt(3)
    v_dot2_f32_bf16 v88, v36, s46, v88
    v_dot2_f32_bf16 v89, v37, s46, v89
    v_dot2_f32_bf16 v90, v38, s46, v90
    v_dot2_f32_bf16 v91, v39, s46, v91
    v_pk_add_f32 v[84:85], v[36:37], v[84:85]
    v_pk_add_f32 v[86:87], v[38:39], v[86:87]
    v_mad_u32_u16 v109, v115, s42, v2
    buffer_load_dwordx4 v[36:39], v109, s[12:15], 0 offen
    v_exp_f32 v16, v84
    v_exp_f32 v17, v85
    v_exp_f32 v18, v86
    v_exp_f32 v19, v87
    v_exp_f32 v20, v88
    v_exp_f32 v21, v89
    v_exp_f32 v22, v90
    v_exp_f32 v23, v91
    v_pk_add_f32 v[16:17], v[16:17], s[44:45]
    v_pk_add_f32 v[18:19], v[18:19], s[44:45]
    v_pk_add_f32 v[20:21], v[20:21], s[44:45]
    v_pk_add_f32 v[22:23], v[22:23], s[44:45]
    v_rcp_f32 v16, v16
    v_rcp_f32 v17, v17
    v_rcp_f32 v18, v18
    v_rcp_f32 v19, v19
    v_rcp_f32 v20, v20
    v_rcp_f32 v21, v21
    v_rcp_f32 v22, v22
    v_rcp_f32 v23, v23
    v_pk_fma_f32 v[120:121], v[84:85], v[16:17], v[120:121]
    v_pk_fma_f32 v[122:123], v[86:87], v[18:19], v[122:123]
    v_pk_fma_f32 v[124:125], v[88:89], v[20:21], v[124:125]
    v_pk_fma_f32 v[126:127], v[90:91], v[22:23], v[126:127]
    s_cmp_ge_u32 s76, s73
    s_cbranch_scc1 B_ex1_0p
    s_waitcnt vmcnt(3)
    v_dot2_f32_bf16 v96, v40, s46, v96
    v_dot2_f32_bf16 v97, v41, s46, v97
    v_dot2_f32_bf16 v98, v42, s46, v98
    v_dot2_f32_bf16 v99, v43, s46, v99
    v_pk_add_f32 v[92:93], v[40:41], v[92:93]
    v_pk_add_f32 v[94:95], v[42:43], v[94:95]
    v_mad_u32_u16 v108, v117, s42, v2
    buffer_load_dwordx4 v[40:43], v108, s[12:15], 0 offen
    v_exp_f32 v16, v92
    v_exp_f32 v17, v93
    v_exp_f32 v18, v94
    v_exp_f32 v19, v95
    v_exp_f32 v20, v96
    v_exp_f32 v21, v97
    v_exp_f32 v22, v98
    v_exp_f32 v23, v99
    v_pk_add_f32 v[16:17], v[16:17], s[44:45]
    v_pk_add_f32 v[18:19], v[18:19], s[44:45]
    v_pk_add_f32 v[20:21], v[20:21], s[44:45]
    v_pk_add_f32 v[22:23], v[22:23], s[44:45]
    v_rcp_f32 v16, v16
    v_rcp_f32 v17, v17
    v_rcp_f32 v18, v18
    v_rcp_f32 v19, v19
    v_rcp_f32 v20, v20
    v_rcp_f32 v21, v21
    v_rcp_f32 v22, v22
    v_rcp_f32 v23, v23
    v_pk_fma_f32 v[120:121], v[92:93], v[16:17], v[120:121]
    v_pk_fma_f32 v[122:123], v[94:95], v[18:19], v[122:123]
    v_pk_fma_f32 v[124:125], v[96:97], v[20:21], v[124:125]
    v_pk_fma_f32 v[126:127], v[98:99], v[22:23], v[126:127]
    s_cmp_ge_u32 s76, s72
    s_cbranch_scc1 B_ex2_0p
    s_waitcnt vmcnt(3)
    v_dot2_f32_bf16 v104, v44, s46, v104
    v_dot2_f32_bf16 v105, v45, s46, v105
    v_dot2_f32_bf16 v106, v46, s46, v106
    v_dot2_f32_bf16 v107, v47, s46, v107
    v_pk_add_f32 v[100:101], v[44:45], v[100:101]
    v_pk_add_f32 v[102:103], v[46:47], v[102:103]
    v_mad_u32_u16 v109, v119, s42, v2
    buffer_load_dwordx4 v[44:47], v109, s[12:15], 0 offen
    v_exp_f32 v16, v100
    v_exp_f32 v17, v101
    v_exp_f32 v18, v102
    v_exp_f32 v19, v103
    v_exp_f32 v20, v104
    v_exp_f32 v21, v105
    v_exp_f32 v22, v106
    v_exp_f32 v23, v107
    v_pk_add_f32 v[16:17], v[16:17], s[44:45]
    v_pk_add_f32 v[18:19], v[18:19], s[44:45]
    v_pk_add_f32 v[20:21], v[20:21], s[44:45]
    v_pk_add_f32 v[22:23], v[22:23], s[44:45]
    v_rcp_f32 v16, v16
    v_rcp_f32 v17, v17
    v_rcp_f32 v18, v18
    v_rcp_f32 v19, v19
    v_rcp_f32 v20, v20
    v_rcp_f32 v21, v21
    v_rcp_f32 v22, v22
    v_rcp_f32 v23, v23
    v_pk_fma_f32 v[120:121], v[100:101], v[16:17], v[120:121]
    v_pk_fma_f32 v[122:123], v[102:103], v[18:19], v[122:123]
    v_pk_fma_f32 v[124:125], v[104:105], v[20:21], v[124:125]
    v_pk_fma_f32 v[126:127], v[106:107], v[22:23], v[126:127]
B_fin_0p:
    v_cvt_f64_f32 v[16:17], v120
    v_cvt_f64_f32 v[18:19], v121
    v_cvt_f64_f32 v[20:21], v122
    v_cvt_f64_f32 v[22:23], v123
    v_cvt_f64_f32 v[24:25], v124
    v_cvt_f64_f32 v[26:27], v125
    v_cvt_f64_f32 v[28:29], v126
    v_cvt_f64_f32 v[30:31], v127
    ds_add_f64 v66, v[16:17] offset:0
    ds_add_f64 v66, v[18:19] offset:64
    ds_add_f64 v66, v[20:21] offset:128
    ds_add_f64 v66, v[22:23] offset:192
    ds_add_f64 v66, v[24:25] offset:256
    ds_add_f64 v66, v[26:27] offset:320
    ds_add_f64 v66, v[28:29] offset:384
    ds_add_f64 v66, v[30:31] offset:448
B_nx_0p:
    s_add_u32 s83, s83, 1
    s_cmp_lt_u32 s83, 2
    s_cbranch_scc1 B_pr4
    s_setprio 2
    s_cmp_lt_u32 s83, 6
    s_cbranch_scc1 B_pr4
    s_setprio 1
    s_cmp_lt_u32 s83, 7
    s_cbranch_scc1 B_pr4
    s_setprio 0
B_pr4:
    s_mov_b32 s76, s77
    s_mov_b32 s77, s78
    s_cmp_ge_u32 s76, s75
    s_cbranch_scc1 B_loop_end
B_loop1p:
    s_waitcnt lgkmcnt(8)
    v_mov_b32 v66, v67
    v_readfirstlane_b32 s78, v64
    s_nop 0
    s_add_u32 s78, s78, 20
    s_sub_u32 s79, s78, s74
    s_min_u32 s79, s79, 51
    s_lshl_b32 s51, s79, 4
    v_add_u32 v108, s51, v13
    ds_read_u16 v111, v108 offset:2656
    v_pk_fma_f32 v[76:77], v[112:113], v[68:69], v[48:49] op_sel_hi:[0,1,1]
    v_pk_fma_f32 v[78:79], v[112:113], v[70:71], v[50:51] op_sel_hi:[0,1,1]
    v_pk_fma_f32 v[80:81], v[112:113], v[72:73], v[52:53] op_sel_hi:[0,1,1]
    v_pk_fma_f32 v[82:83], v[112:113], v[74:75], v[54:55] op_sel_hi:[0,1,1]
    v_pk_fma_f32 v[84:85], v[114:115], v[68:69], v[48:49] op_sel_hi:[0,1,1]
    v_pk_fma_f32 v[86:87], v[114:115], v[70:71], v[50:51] op_sel_hi:[0,1,1]
    v_pk_fma_f32 v[88:89], v[114:115], v[72:73], v[52:53] op_sel_hi:[0,1,1]
    v_pk_fma_f32 v[90:91], v[114:115], v[74:75], v[54:55] op_sel_hi:[0,1,1]
    v_pk_fma_f32 v[92:93], v[116:117], v[68:69], v[48:49] op_sel_hi:[0,1,1]
    v_pk_fma_f32 v[94:95], v[116:117], v[70:71], v[50:51] op_sel_hi:[0,1,1]
    v_pk_fma_f32 v[96:97], v[116:117], v[72:73], v[52:53] op_sel_hi:[0,1,1]
    v_pk_fma_f32 v[98:99], v[116:117], v[74:75], v[54:55] op_sel_hi:[0,1,1]
    v_pk_fma_f32 v[100:101], v[118:119], v[68:69], v[48:49] op_sel_hi:[0,1,1]
    v_pk_fma_f32 v[102:103], v[118:119], v[70:71], v[50:51] op_sel_hi:[0,1,1]
    v_pk_fma_f32 v[104:105], v[118:119], v[72:73], v[52:53] op_sel_hi:[0,1,1]
    v_pk_fma_f32 v[106:107], v[118:119], v[74:75], v[54:55] op_sel_hi:[0,1,1]
    v_mad_u32_u16 v110, v57, 36, v2 op_sel:[1,0,0,0]
    ds_read_b128 v[48:51], v110 offset:55296
    ds_read_b128 v[52:55], v110 offset:55424
    v_mad_u32_u16 v67, v57, s84, v3 op_sel:[1,0,0,0]
    s_waitcnt lgkmcnt(2)
    ds_read_b128 v[112:115], v111 offset:3488
    ds_read_b128 v[116:119], v111 offset:3504
    s_mov_b64 exec, 1
    ds_add_rtn_u32 v64, v14, v15
    s_mov_b64 exec, -1
    s_waitcnt vmcnt(3)
    v_dot2_f32_bf16 v80, v32, s46, v80
    v_dot2_f32_bf16 v81, v33, s46, v81
    v_dot2_f32_bf16 v82, v34, s46, v82
    v_dot2_f32_bf16 v83, v35, s46, v83
    v_pk_add_f32 v[76:77], v[32:33], v[76:77]
    v_pk_add_f32 v[78:79], v[34:35], v[78:79]
    v_mad_u32_u16 v108, v57, s42, v2
    buffer_load_dwordx4 v[32:35], v108, s[12:15], 0 offen
    v_exp_f32 v16, v76
    v_exp_f32 v17, v77
    v_exp_f32 v18, v78
    v_exp_f32 v19, v79
    v_exp_f32 v20, v80
    v_exp_f32 v21, v81
    v_exp_f32 v22, v82
    v_exp_f32 v23, v83
    v_pk_add_f32 v[16:17], v[16:17], s[44:45]
    v_pk_add_f32 v[18:19], v[18:19], s[44:45]
    v_pk_add_f32 v[20:21], v[20:21], s[44:45]
    v_pk_add_f32 v[22:23], v[22:23], s[44:45]
    v_rcp_f32 v16, v16
    v_rcp_f32 v17, v17
    v_rcp_f32 v18, v18
    v_rcp_f32 v19, v19
    v_rcp_f32 v20, v20
    v_rcp_f32 v21, v21
    v_rcp_f32 v22, v22
    v_rcp_f32 v23, v23
    v_pk_mul_f32 v[120:121], v[76:77], v[16:17]
    v_pk_mul_f32 v[122:123], v[78:79], v[18:19]
    v_pk_mul_f32 v[124:125], v[80:81], v[20:21]
    v_pk_mul_f32 v[126:127], v[82:83], v[22:23]
    s_cmp_ge_u32 s76, s82
    s_cbranch_scc1 B_ex0_1p
    s_waitcnt vmcnt(3)
    v_dot2_f32_bf16 v88, v36, s46, v88
    v_dot2_f32_bf16 v89, v37, s46, v89
    v_dot2_f32_bf16 v90, v38, s46, v90
    v_dot2_f32_bf16 v91, v39, s46, v91
    v_pk_add_f32 v[84:85], v[36:37], v[84:85]
    v_pk_add_f32 v[86:87], v[38:39], v[86:87]
    v_mad_u32_u16 v109, v59, s42, v2
    buffer_load_dwordx4 v[36:39], v109, s[12:15], 0 offen
    v_exp_f32 v16, v84
    v_exp_f32 v17, v85
    v_exp_f32 v18, v86
    v_exp_f32 v19, v87
    v_exp_f32 v20, v88
    v_exp_f32 v21, v89
    v_exp_f32 v22, v90
    v_exp_f32 v23, v91
    v_pk_add_f32 v[16:17], v[16:17], s[44:45]
    v_pk_add_f32 v[18:19], v[18:19], s[44:45]
    v_pk_add_f32 v[20:21], v[20:21], s[44:45]
    v_pk_add_f32 v[22:23], v[22:23], s[44:45]
    v_rcp_f32 v16, v16
    v_rcp_f32 v17, v17
    v_rcp_f32 v18, v18
    v_rcp_f32 v19, v19
    v_rcp_f32 v20, v20
    v_rcp_f32 v21, v21
    v_rcp_f32 v22, v22
    v_rcp_f32 v23, v23
    v_pk_fma_f32 v[120:121], v[84:85], v[16:17], v[120:121]
    v_pk_fma_f32 v[122:123], v[86:87], v[18:19], v[122:123]
    v_pk_fma_f32 v[124:125], v[88:89], v[20:21], v[124:125]
    v_pk_fma_f32 v[126:127], v[90:91], v[22:23], v[126:127]
    s_cmp_ge_u32 s76, s73
    s_cbranch_scc1 B_ex1_1p
    s_waitcnt vmcnt(3)
    v_dot2_f32_bf16 v96, v40, s46, v96
    v_dot2_f32_bf16 v97, v41, s46, v97
    v_dot2_f32_bf16 v98, v42, s46, v98
    v_dot2_f32_bf16 v99, v43, s46, v99
    v_pk_add_f32 v[92:93], v[40:41], v[92:93]
    v_pk_add_f32 v[94:95], v[42:43], v[94:95]
    v_mad_u32_u16 v108, v61, s42, v2
    buffer_load_dwordx4 v[40:43], v108, s[12:15], 0 offen
    v_exp_f32 v16, v92
    v_exp_f32 v17, v93
    v_exp_f32 v18, v94
    v_exp_f32 v19, v95
    v_exp_f32 v20, v96
    v_exp_f32 v21, v97
    v_exp_f32 v22, v98
    v_exp_f32 v23, v99
    v_pk_add_f32 v[16:17], v[16:17], s[44:45]
    v_pk_add_f32 v[18:19], v[18:19], s[44:45]
    v_pk_add_f32 v[20:21], v[20:21], s[44:45]
    v_pk_add_f32 v[22:23], v[22:23], s[44:45]
    v_rcp_f32 v16, v16
    v_rcp_f32 v17, v17
    v_rcp_f32 v18, v18
    v_rcp_f32 v19, v19
    v_rcp_f32 v20, v20
    v_rcp_f32 v21, v21
    v_rcp_f32 v22, v22
    v_rcp_f32 v23, v23
    v_pk_fma_f32 v[120:121], v[92:93], v[16:17], v[120:121]
    v_pk_fma_f32 v[122:123], v[94:95], v[18:19], v[122:123]
    v_pk_fma_f32 v[124:125], v[96:97], v[20:21], v[124:125]
    v_pk_fma_f32 v[126:127], v[98:99], v[22:23], v[126:127]
    s_cmp_ge_u32 s76, s72
    s_cbranch_scc1 B_ex2_1p
    s_waitcnt vmcnt(3)
    v_dot2_f32_bf16 v104, v44, s46, v104
    v_dot2_f32_bf16 v105, v45, s46, v105
    v_dot2_f32_bf16 v106, v46, s46, v106
    v_dot2_f32_bf16 v107, v47, s46, v107
    v_pk_add_f32 v[100:101], v[44:45], v[100:101]
    v_pk_add_f32 v[102:103], v[46:47], v[102:103]
    v_mad_u32_u16 v109, v63, s42, v2
    buffer_load_dwordx4 v[44:47], v109, s[12:15], 0 offen
    v_exp_f32 v16, v100
    v_exp_f32 v17, v101
    v_exp_f32 v18, v102
    v_exp_f32 v19, v103
    v_exp_f32 v20, v104
    v_exp_f32 v21, v105
    v_exp_f32 v22, v106
    v_exp_f32 v23, v107
    v_pk_add_f32 v[16:17], v[16:17], s[44:45]
    v_pk_add_f32 v[18:19], v[18:19], s[44:45]
    v_pk_add_f32 v[20:21], v[20:21], s[44:45]
    v_pk_add_f32 v[22:23], v[22:23], s[44:45]
    v_rcp_f32 v16, v16
    v_rcp_f32 v17, v17
    v_rcp_f32 v18, v18
    v_rcp_f32 v19, v19
    v_rcp_f32 v20, v20
    v_rcp_f32 v21, v21
    v_rcp_f32 v22, v22
    v_rcp_f32 v23, v23
    v_pk_fma_f32 v[120:121], v[100:101], v[16:17], v[120:121]
    v_pk_fma_f32 v[122:123], v[102:103], v[18:19], v[122:123]
    v_pk_fma_f32 v[124:125], v[104:105], v[20:21], v[124:125]
    v_pk_fma_f32 v[126:127], v[106:107], v[22:23], v[126:127]
B_fin_1p:
    v_cvt_f64_f32 v[16:17], v120
    v_cvt_f64_f32 v[18:19], v121
    v_cvt_f64_f32 v[20:21], v122
    v_cvt_f64_f32 v[22:23], v123
    v_cvt_f64_f32 v[24:25], v124
    v_cvt_f64_f32 v[26:27], v125
    v_cvt_f64_f32 v[28:29], v126
    v_cvt_f64_f32 v[30:31], v127
    ds_add_f64 v66, v[16:17] offset:0
    ds_add_f64 v66, v[18:19] offset:64
    ds_add_f64 v66, v[20:21] offset:128
    ds_add_f64 v66, v[22:23] offset:192
    ds_add_f64 v66, v[24:25] offset:256
    ds_add_f64 v66, v[26:27] offset:320
    ds_add_f64 v66, v[28:29] offset:384
    ds_add_f64 v66, v[30:31] offset:448
B_nx_1p:
    s_add_u32 s83, s83, 1
    s_cmp_lt_u32 s83, 2
    s_cbranch_scc1 B_pr5
    s_setprio 2
    s_cmp_lt_u32 s83, 6
    s_cbranch_scc1 B_pr5
    s_setprio 1
    s_cmp_lt_u32 s83, 7
    s_cbranch_scc1 B_pr5
    s_setprio 0
B_pr5:
    s_mov_b32 s76, s77
    s_mov_b32 s77, s78
    s_cmp_ge_u32 s76, s75
    s_cbranch_scc1 B_loop_end
    s_branch B_loop0p
B_ex0_0p:
    v_mad_u32_u16 v109, v115, s42, v2
    buffer_load_dwordx4 v[36:39], v109, s[12:15], 0 offen
    v_mad_u32_u16 v108, v117, s42, v2
    buffer_load_dwordx4 v[40:43], v108, s[12:15], 0 offen
    v_mad_u32_u16 v109, v119, s42, v2
    buffer_load_dwordx4 v[44:47], v109, s[12:15], 0 offen
    s_branch B_fin_0p
B_ex1_0p:
    v_mad_u32_u16 v108, v117, s42, v2
    buffer_load_dwordx4 v[40:43], v108, s[12:15], 0 offen
    v_mad_u32_u16 v109, v119, s42, v2
    buffer_load_dwordx4 v[44:47], v109, s[12:15], 0 offen
    s_branch B_fin_0p
B_ex2_0p:
    v_mad_u32_u16 v109, v119, s42, v2
    buffer_load_dwordx4 v[44:47], v109, s[12:15], 0 offen
    s_branch B_fin_0p
B_ex0_1p:
    v_mad_u32_u16 v109, v59, s42, v2
    buffer_load_dwordx4 v[36:39], v109, s[12:15], 0 offen
    v_mad_u32_u16 v108, v61, s42, v2
    buffer_load_dwordx4 v[40:43], v108, s[12:15], 0 offen
    v_mad_u32_u16 v109, v63, s42, v2
    buffer_load_dwordx4 v[44:47], v109, s[12:15], 0 offen
    s_branch B_fin_1p
B_ex1_1p:
    v_mad_u32_u16 v108, v61, s42, v2
    buffer_load_dwordx4 v[40:43], v108, s[12:15], 0 offen
    v_mad_u32_u16 v109, v63, s42, v2
    buffer_load_dwordx4 v[44:47], v109, s[12:15], 0 offen
    s_branch B_fin_1p
B_ex2_1p:
    v_mad_u32_u16 v109, v63, s42, v2
    buffer_load_dwordx4 v[44:47], v109, s[12:15], 0 offen
    s_branch B_fin_1p
B_loop_end:
    s_waitcnt vmcnt(0) lgkmcnt(0)
    v_lshlrev_b32 v11, 4, v1
    v_and_b32 v8, 31, v1
    v_add_u32 v8, s38, v8
    v_lshrrev_b32 v9, 5, v1
    s_cmp_ge_u32 s3, 8
    s_cbranch_scc1 B_join
    s_add_u32 s39, s41, 8192
    buffer_load_dwordx4 v[100:103], v11, s[20:23], s39 offen offset:0
    buffer_load_dwordx4 v[104:107], v11, s[20:23], s39 offen offset:1024
    buffer_load_dwordx4 v[108:111], v11, s[20:23], s39 offen offset:2048
    buffer_load_dwordx4 v[4:7], v11, s[20:23], s39 offen offset:3072
    s_add_u32 s39, s41, 154144
    v_add_u32 v98, s39, v11
    v_and_b32 v13, 7, v1
    v_xor_b32 v13, v13, v9
    v_lshlrev_b32 v14, 7, v8
    v_add_u32 v14, 140832, v14
    v_xor_b32 v15, 0, v13
    v_lshl_add_u32 v92, v15, 4, v14
    ds_read_b128 v[16:19], v92
    v_xor_b32 v15, 2, v13
    v_lshl_add_u32 v93, v15, 4, v14
    ds_read_b128 v[20:23], v93
    v_xor_b32 v15, 4, v13
    v_lshl_add_u32 v94, v15, 4, v14
    ds_read_b128 v[24:27], v94
    v_xor_b32 v15, 6, v13
    v_lshl_add_u32 v95, v15, 4, v14
    ds_read_b128 v[28:31], v95
    s_waitcnt vmcnt(0) lgkmcnt(0)
    v_mfma_f32_32x32x16_bf16 v[112:127], v[100:103], v[16:19], 0
    v_mfma_f32_32x32x16_bf16 v[112:127], v[104:107], v[20:23], v[112:127]
    v_mfma_f32_32x32x16_bf16 v[112:127], v[108:111], v[24:27], v[112:127]
    v_mfma_f32_32x32x16_bf16 v[112:127], v[4:7], v[28:31], v[112:127]
B_join:
    v_lshrrev_b32 v12, 3, v0
    s_movk_i32 s51, 576
    v_mul_u32_u24 v96, s51, v12
    v_add_u32 v96, v96, v2
    v_add_u32 v96, 83808, v96
    v_and_b32 v97, 7, v12
    v_lshlrev_b32 v97, 4, v97
    v_xor_b32 v97, v97, v2
    v_lshl_add_u32 v97, v12, 7, v97
    s_setprio 0
    s_waitcnt lgkmcnt(0)
    s_barrier
    s_cmp_eq_u32 s87, -1
    s_cbranch_scc1 B_nb
    s_add_u32 s87, s87, 1
    s_cmp_lt_u32 s87, 128
    s_cbranch_scc1 B_again
    s_mov_b32 s87, -1
B_nb:
    s_add_u32 s50, s50, 32
    s_cmp_eq_u32 s71, 0
    s_cbranch_scc1 B_fin
B_again:
    s_waitcnt vmcnt(0)
    v_lshrrev_b32 v4, 3, v0
    v_lshlrev_b32 v12, 10, v4
    buffer_load_dword v6, v12, s[4:7], s32 offen
    buffer_load_dword v7, v12, s[4:7], s33 offen
    s_branch B_batch
B_fin:
    s_cmp_ge_u32 s3, 13
    s_cbranch_scc1 B_done2
    ds_read_b128 v[64:67], v96 offset:0
    ds_read_b128 v[68:71], v96 offset:128
    ds_read_b128 v[72:75], v96 offset:256
    ds_read_b128 v[76:79], v96 offset:384
    s_waitcnt lgkmcnt(3)
    v_cvt_f32_f64 v80, v[64:65]
    v_cvt_f32_f64 v81, v[66:67]
    s_waitcnt lgkmcnt(2)
    v_cvt_f32_f64 v82, v[68:69]
    v_cvt_f32_f64 v83, v[70:71]
    s_waitcnt lgkmcnt(1)
    v_cvt_f32_f64 v84, v[72:73]
    v_cvt_f32_f64 v85, v[74:75]
    s_waitcnt lgkmcnt(0)
    v_cvt_f32_f64 v86, v[76:77]
    v_cvt_f32_f64 v87, v[78:79]
    v_pk_mul_f32 v[80:81], v[80:81], s[48:49]
    v_pk_mul_f32 v[82:83], v[82:83], s[48:49]
    v_pk_mul_f32 v[84:85], v[84:85], s[48:49]
    v_pk_mul_f32 v[86:87], v[86:87], s[48:49]
    v_cvt_pk_bf16_f32 v88, v80, v81
    v_cvt_pk_bf16_f32 v89, v82, v83
    v_cvt_pk_bf16_f32 v90, v84, v85
    v_cvt_pk_bf16_f32 v91, v86, v87
    ds_write_b128 v97, v[88:91] offset:3488
    s_cmp_ge_u32 s3, 8
    s_cbranch_scc1 B_b4
    ds_read_b128 v[48:51], v98 offset:0
    v_add_u32 v92, -137344, v92
    ds_read_b128 v[52:55], v98 offset:1024
    v_add_u32 v93, -137344, v93
    ds_read_b128 v[56:59], v98 offset:2048
    v_add_u32 v94, -137344, v94
    ds_read_b128 v[60:63], v98 offset:3072
    v_add_u32 v95, -137344, v95
    s_waitcnt lgkmcnt(4)
    s_branch B_b4x
B_b4:
    s_waitcnt lgkmcnt(0)
B_b4x:
    s_barrier
    s_cmp_ge_u32 s3, 8
    s_cbranch_scc1 B_b5
    ds_read_b128 v[32:35], v92
    ds_read_b128 v[36:39], v93
    ds_read_b128 v[40:43], v94
    ds_read_b128 v[44:47], v95
    s_movk_i32 s51, 272
    v_mul_u32_u24 v17, s51, v8
    v_lshl_add_u32 v17, v9, 6, v17
    s_lshl_b32 s51, s34, 7
    s_add_u32 s51, s51, 83808
    v_add_u32 v17, s51, v17
    s_waitcnt lgkmcnt(3)
    v_mfma_f32_32x32x16_bf16 v[112:127], v[48:51], v[32:35], v[112:127]
    s_waitcnt lgkmcnt(2)
    v_mfma_f32_32x32x16_bf16 v[112:127], v[52:55], v[36:39], v[112:127]
    s_waitcnt lgkmcnt(1)
    v_mfma_f32_32x32x16_bf16 v[112:127], v[56:59], v[40:43], v[112:127]
    s_waitcnt lgkmcnt(0)
    v_mfma_f32_32x32x16_bf16 v[112:127], v[60:63], v[44:47], v[112:127]
    s_nop 11
    ds_write_b128 v17, v[112:115] offset:0
    ds_write_b128 v17, v[116:119] offset:16
    ds_write_b128 v17, v[120:123] offset:32
    ds_write_b128 v17, v[124:127] offset:48
B_b5:
    s_movk_i32 s51, 272
    v_mul_u32_u24 v18, s51, v12
    v_lshl_add_u32 v18, v2, 1, v18
    v_add_u32 v18, 83808, v18
    v_lshlrev_b32 v19, 4, v0
    s_lshl_b32 s51, s37, 7
    v_cmp_gt_u32 vcc, 784, v0
    s_mov_b32 s52, s47
    s_mov_b32 s53, s47
    s_waitcnt lgkmcnt(0)
    s_barrier
    ds_read_b128 v[32:35], v18
    ds_read_b128 v[36:39], v18 offset:16
    s_waitcnt lgkmcnt(0)
    v_pk_mul_f32 v[64:65], v[32:33], s[52:53]
    v_pk_mul_f32 v[66:67], v[34:35], s[52:53]
    v_pk_mul_f32 v[68:69], v[36:37], s[52:53]
    v_pk_mul_f32 v[70:71], v[38:39], s[52:53]
    v_exp_f32 v64, v64
    v_exp_f32 v65, v65
    v_exp_f32 v66, v66
    v_exp_f32 v67, v67
    v_exp_f32 v68, v68
    v_exp_f32 v69, v69
    v_exp_f32 v70, v70
    v_exp_f32 v71, v71
    v_pk_add_f32 v[64:65], v[64:65], s[44:45]
    v_pk_add_f32 v[66:67], v[66:67], s[44:45]
    v_pk_add_f32 v[68:69], v[68:69], s[44:45]
    v_pk_add_f32 v[70:71], v[70:71], s[44:45]
    v_rcp_f32 v64, v64
    v_rcp_f32 v65, v65
    v_rcp_f32 v66, v66
    v_rcp_f32 v67, v67
    v_rcp_f32 v68, v68
    v_rcp_f32 v69, v69
    v_rcp_f32 v70, v70
    v_rcp_f32 v71, v71
    v_pk_mul_f32 v[64:65], v[64:65], v[32:33]
    v_pk_mul_f32 v[66:67], v[66:67], v[34:35]
    v_pk_mul_f32 v[68:69], v[68:69], v[36:37]
    v_pk_mul_f32 v[70:71], v[70:71], v[38:39]
    v_cvt_pk_bf16_f32 v40, v64, v65
    v_cvt_pk_bf16_f32 v41, v66, v67
    v_cvt_pk_bf16_f32 v42, v68, v69
    v_cvt_pk_bf16_f32 v43, v70, v71
    s_and_b64 exec, exec, vcc
    buffer_store_dwordx4 v[40:43], v19, s[24:27], s51 offen sc0 sc1
B_done2:
B_done:
    s_endpgm
.section .rodata,"a"
.p2align 6
.amdhsa_kernel mpnn_bin_kernel
  .amdhsa_next_free_vgpr 128
  .amdhsa_next_free_sgpr 100
  .amdhsa_accum_offset 128
  .amdhsa_group_segment_fixed_size 0
  .amdhsa_kernarg_size 72
  .amdhsa_user_sgpr_count 2
  .amdhsa_user_sgpr_kernarg_segment_ptr 1
  .amdhsa_system_sgpr_workgroup_id_x 1
.end_amdhsa_kernel
.p2align 6
.amdhsa_kernel mpnn_main_kernel
  .amdhsa_next_free_vgpr 128
  .amdhsa_next_free_sgpr 100
  .amdhsa_accum_offset 128
  .amdhsa_group_segment_fixed_size 0
  .amdhsa_kernarg_size 72
  .amdhsa_user_sgpr_count 2
  .amdhsa_user_sgpr_kernarg_segment_ptr 1
  .amdhsa_system_sgpr_workgroup_id_x 1
.end_amdhsa_kernel
```
